```python
import torch

def _softmax(x, axis=-1):
    return torch.softmax(x, dim=axis)
def _gelu(x):
    return torch.nn.functional.gelu(x, approximate="tanh")
def _silu(x):
    return torch.nn.functional.silu(x)
def _sigmoid(x):
    return torch.sigmoid(x)
def _layernorm(x, axis=-1, eps=1e-5):
    m = x.mean(dim=axis, keepdim=True)
    v = x.var(dim=axis, keepdim=True, unbiased=False)
    return (x - m) / torch.sqrt(v + eps)
def _scatter_add(tgt, idx, src, axis=0):
    return tgt.clone().index_add_(axis, idx, src)
def _segment_sum(src, seg, n):
    out = torch.zeros((n,) + src.shape[1:], dtype=src.dtype)
    return out.index_add_(0, seg, src)
def _pad(x, pw):
    flat = tuple(v for pair in reversed(pw) for v in pair)
    return torch.nn.functional.pad(x, flat)

kernel_name = 'sequential_preLN__linear_kernel_hedgehog__glu_gated_bilinear__prompt'

def setup_inputs():

    _w = (lambda a: (lambda t: t.to(torch.bfloat16) if t.is_floating_point() else t)(torch.as_tensor(a)))
    def _A_setup():
        B, S, D, H = 1, 2048, 512, 32
        Dh = D // H
        return {
            "x": _w((lambda *s: torch.randn(*s, dtype=torch.bfloat16) * 0.05)(B, S, D)),
            "wqkv": _w((lambda *s: torch.randn(*s, dtype=torch.bfloat16) * 0.2)(D, 3 * D)),
            "w_phi": _w((lambda *s: torch.randn(*s, dtype=torch.bfloat16) * 0.2)(H, Dh, Dh) * (Dh ** -0.5)),
            "wo": _w((lambda *s: torch.randn(*s, dtype=torch.bfloat16) * 0.05)(D, D)),
        }
    _A_in = _A_setup()

    def _B_setup():
        B, S, D, F = 1, 2048, 512, 1376
        return {
            "x": _w((lambda *s: torch.randn(*s, dtype=torch.bfloat16) * 0.05)(B, S, D)),
            "w_gate": _w((lambda *s: torch.randn(*s, dtype=torch.bfloat16) * 0.4)(D, F) * (D ** -0.5)),
            "w_up": _w((lambda *s: torch.randn(*s, dtype=torch.bfloat16) * 0.4)(D, F) * (D ** -0.5)),
            "w_down": _w((lambda *s: torch.randn(*s, dtype=torch.bfloat16) * 0.4)(F, D) * (F ** -0.5)),
        }
    _B_in = _B_setup()

    return {
        "A_x": _A_in["x"],
        "A_wqkv": _A_in["wqkv"],
        "A_w_phi": _A_in["w_phi"],
        "A_wo": _A_in["wo"],
        "B_x": _B_in["x"],
        "B_w_gate": _B_in["w_gate"],
        "B_w_up": _B_in["w_up"],
        "B_w_down": _B_in["w_down"],
    }

def reference(A_x, A_wqkv, A_w_phi, A_wo, B_x, B_w_gate, B_w_up, B_w_down):
    def _A_ref(x, wqkv, w_phi, wo):
        B, S, D = x.shape
        H = 32; Dh = D // H
        qkv = (lambda x, *d: x.permute(*d))((x @ wqkv).reshape(B, S, 3, H, Dh), 2, 0, 3, 1, 4)
        q, k, v = qkv[0], qkv[1], qkv[2]
        pq = torch.einsum("bhsd,hdf->bhsf", q, w_phi)
        pk = torch.einsum("bhsd,hdf->bhsf", k, w_phi)
        phi_q = torch.concatenate([_softmax(pq, axis=-1), _softmax(-pq, axis=-1)], axis=-1)
        phi_k = torch.concatenate([_softmax(pk, axis=-1), _softmax(-pk, axis=-1)], axis=-1)
        kv = torch.einsum("bhsf,bhsd->bhfd", phi_k, v)
        z  = torch.einsum("bhsf->bhf", phi_k)
        num = torch.einsum("bhqf,bhfd->bhqd", phi_q, kv)
        den = torch.einsum("bhqf,bhf->bhq", phi_q, z)[..., None] + 1e-6
        o = num / den
        return (lambda x, *d: x.permute(*d))(o, 0, 2, 1, 3).reshape(B, S, D) @ wo

    def _B_ref(x, w_gate, w_up, w_down):
        g = torch.einsum("bsd,df->bsf", x, w_gate)
        u = torch.einsum("bsd,df->bsf", x, w_up)
        h = g * u
        return torch.einsum("bsf,fd->bsd", h, w_down)

    x = A_x
    h = x + _A_ref(_layernorm(x, axis=-1), A_wqkv, A_w_phi, A_wo)
    h2 = h + _B_ref(_layernorm(h, axis=-1), B_w_gate, B_w_up, B_w_down)
    return h2
```

```asm
; @launch grid=(256,1,1) block=(256,1,1) lds=163840
.amdgcn_target "amdgcn-amd-amdhsa--gfx950"
.text
.globl sequential_preLN__linear_kernel_hedgehog__glu_gated_bilinear__prompt_kernel
.p2align 12
.fill 832, 4, 0xbf810000
.p2align 8
.type sequential_preLN__linear_kernel_hedgehog__glu_gated_bilinear__prompt_kernel,@function
sequential_preLN__linear_kernel_hedgehog__glu_gated_bilinear__prompt_kernel:
    s_load_dwordx16 s[4:19], s[0:1], 0
    s_getpc_b64 s[36:37]
L_pc:
    s_lshr_b32 s72, s2, 3
    s_lshl_b32 s72, s72, 10
    s_mov_b32 s38, L_end-L_pc
    s_mov_b32 s39, 0x00020000
    s_and_b32 s37, s37, 0xffff
    v_lshl_add_u32 v1, v0, 2, s72
    buffer_load_dword v116, v1, s[36:39], 0 offen
    s_cmpk_ge_u32 s2, 256
    s_cbranch_scc1 L_end
    v_lshrrev_b32 v1, 6, v0
    v_and_b32 v0, 63, v0
    v_readfirstlane_b32 s68, v1
    s_and_b32 s92, s2, 7
    s_lshr_b32 s93, s2, 3
    s_and_b32 s69, s93, 1
    s_lshl_b32 s94, s92, 1
    s_add_u32 s69, s69, s94
    s_lshr_b32 s70, s2, 4
    v_lshlrev_b32 v12, 4, v0
    v_lshrrev_b32 v110, 4, v0
    v_and_b32 v111, 7, v0
    v_xor_b32 v110, v110, v111
    v_lshlrev_b32 v110, 4, v110
    v_lshrrev_b32 v111, 3, v0
    v_lshl_add_u32 v1, v111, 10, v110
    v_xor_b32 v2, 64, v1
    v_lshrrev_b32 v110, 2, v0
    v_mul_u32_u24 v110, 3072, v110
    v_and_b32 v111, 3, v0
    v_lshl_add_u32 v3, v111, 4, v110
    s_lshl_b32 s92, s69, 17
    s_lshl_b32 s93, s68, 15
    s_add_u32 s92, s92, s93
    s_lshl_b32 s93, s70, 6
    s_xor_b32 s93, s93, 512
    s_mul_i32 s96, s68, 49152
    s_add_u32 s93, s93, s96
    s_lshr_b32 s96, s70, 2
    s_xor_b32 s96, s96, s69
    s_lshl1_add_u32 s96, s96, s70
    s_and_b32 s97, s70, 2
    s_sub_u32 s96, s96, s97
    s_lshr_b32 s97, s97, 1
    s_lshl1_add_u32 s96, s96, s97
    s_add_u32 s96, s96, s2
    s_lshl_b32 s96, s96, 2
    s_lshr_b32 s96, 0x76545210, s96
    s_add_u32 s97, s96, 0
    s_and_b32 s97, s97, 7
    s_lshl_b32 s76, s97, 7
    s_add_u32 s76, s76, s92
    s_mul_i32 s84, s97, 196608
    s_add_u32 s84, s84, s93
    s_lshl_b32 s73, s68, 10
    s_mov_b32 s30, 2097152
    s_mov_b32 s31, 0x00020000
    s_mov_b32 s34, 1572864
    s_mov_b32 s35, 0x00020000
    s_waitcnt lgkmcnt(0)
    s_mov_b32 s28, s4
    s_and_b32 s29, s5, 0xffff
    s_mov_b32 s32, s6
    s_and_b32 s33, s7, 0xffff
    s_lshl1_add_u32 m0, s73, 15360
    s_nop 0
    buffer_load_dwordx4 v3, s[32:35], s84 offen offset:1024 lds
    buffer_load_dwordx4 v3, s[32:35], s84 offen offset:2048 lds
    s_lshl2_add_u32 m0, s73, 0
    s_nop 0
    buffer_load_dwordx4 v1, s[28:31], s76 offen lds
    s_add_u32 s76, s76, 8192
    s_lshl2_add_u32 m0, s73, 1024
    s_nop 0
    buffer_load_dwordx4 v2, s[28:31], s76 offen lds
    s_add_u32 s76, s76, 8192
    s_lshl2_add_u32 m0, s73, 2048
    s_nop 0
    buffer_load_dwordx4 v1, s[28:31], s76 offen lds
    s_add_u32 s76, s76, 8192
    s_lshl2_add_u32 m0, s73, 3072
    s_nop 0
    buffer_load_dwordx4 v2, s[28:31], s76 offen lds
    s_load_dwordx4 s[20:23], s[0:1], 64
    s_load_dwordx2 s[24:25], s[0:1], 80
    s_add_u32 s97, s96, 1
    s_and_b32 s97, s97, 7
    s_lshl_b32 s77, s97, 7
    s_add_u32 s77, s77, s92
    s_mul_i32 s85, s97, 196608
    s_add_u32 s85, s85, s93
    s_lshl2_add_u32 m0, s73, 24704
    s_nop 0
    buffer_load_dwordx4 v1, s[28:31], s77 offen lds
    s_add_u32 s77, s77, 8192
    s_lshl2_add_u32 m0, s73, 25728
    s_nop 0
    buffer_load_dwordx4 v2, s[28:31], s77 offen lds
    v_lshlrev_b32 v119, 7, v0
    s_lshr_b32 s3, s68, 1
    s_lshl1_add_u32 s3, s2, s3
    s_mul_i32 s3, s3, 3072
    s_and_b32 s75, s68, 1
    s_lshl_b32 s75, s75, 9
    s_add_u32 s3, s3, s75
    s_mov_b64 exec, 15
    buffer_load_dword a249, v119, s[32:35], s3 offen
    s_mov_b64 exec, -1
    s_mov_b32 s36, s8
    s_and_b32 s37, s9, 0xffff
    s_mov_b32 s38, 16384
    s_mov_b32 s39, 0x00020000
    s_lshl_b32 s72, s70, 10
    s_xor_b32 s72, s72, 8192
    s_mov_b32 m0, 156416
    s_nop 0
    buffer_load_dwordx4 v12, s[36:39], s72 offen  lds
    s_mov_b32 s40, s10
    s_and_b32 s41, s11, 0xffff
    s_mov_b32 s42, 524288
    s_mov_b32 s43, 0x00020000
    v_lshlrev_b32 v119, 7, v0
    s_lshl2_add_u32 s3, s2, s68
    s_lshl_b32 s3, s3, 9
    s_mov_b64 exec, 15
    buffer_load_dword a248, v119, s[40:43], s3 offen
    s_mov_b64 exec, -1
    s_add_u32 s97, s96, 2
    s_and_b32 s97, s97, 7
    s_lshl_b32 s78, s97, 7
    s_add_u32 s78, s78, s92
    s_mul_i32 s86, s97, 196608
    s_add_u32 s86, s86, s93
    s_add_u32 s97, s96, 3
    s_and_b32 s97, s97, 7
    s_lshl_b32 s79, s97, 7
    s_add_u32 s79, s79, s92
    s_mul_i32 s87, s97, 196608
    s_add_u32 s87, s87, s93
    s_add_u32 s97, s96, 4
    s_and_b32 s97, s97, 7
    s_lshl_b32 s80, s97, 7
    s_add_u32 s80, s80, s92
    s_mul_i32 s88, s97, 196608
    s_add_u32 s88, s88, s93
    s_add_u32 s97, s96, 5
    s_and_b32 s97, s97, 7
    s_lshl_b32 s81, s97, 7
    s_add_u32 s81, s81, s92
    s_mul_i32 s89, s97, 196608
    s_add_u32 s89, s89, s93
    s_add_u32 s97, s96, 6
    s_and_b32 s97, s97, 7
    s_lshl_b32 s82, s97, 7
    s_add_u32 s82, s82, s92
    s_mul_i32 s90, s97, 196608
    s_add_u32 s90, s90, s93
    s_add_u32 s97, s96, 7
    s_and_b32 s97, s97, 7
    s_lshl_b32 s83, s97, 7
    s_add_u32 s83, s83, s92
    s_mul_i32 s91, s97, 196608
    s_add_u32 s91, s91, s93
    s_waitcnt lgkmcnt(0)
    s_mov_b32 s60, s22
    s_and_b32 s61, s23, 0xffff
    s_mov_b32 s62, 256
    s_mov_b32 s63, 0x00020000
    s_or_b32 s92, s2, s68
    s_cmp_lg_u32 s92, 0
    s_cbranch_scc1 NON_1
    s_memrealtime s[74:75]
    s_waitcnt lgkmcnt(0)
    s_or_b32 s75, s75, 0x80000000
    v_mov_b32 v120, s74
    v_mov_b32 v121, s75
    s_mov_b64 exec, 1
    buffer_store_dwordx2 v[120:121], v12, s[60:63], 0 offen sc1
    s_mov_b64 exec, -1
    s_nop 1
NON_1:
    s_mov_b32 s44, s14
    s_and_b32 s45, s15, 0xffff
    s_mov_b32 s46, 1409024
    s_mov_b32 s47, 0x00020000
    s_mov_b32 s48, s16
    s_and_b32 s49, s17, 0xffff
    s_mov_b32 s50, 1409024
    s_mov_b32 s51, 0x00020000
    s_mov_b32 s52, s18
    s_and_b32 s53, s19, 0xffff
    s_mov_b32 s54, 1409024
    s_mov_b32 s55, 0x00020000
    s_mov_b32 s40, s10
    s_and_b32 s41, s11, 0xffff
    s_mov_b32 s42, 524288
    s_mov_b32 s43, 0x00020000
    s_mov_b32 s56, s20
    s_and_b32 s57, s21, 0xffff
    s_mov_b32 s58, 2097152
    s_mov_b32 s59, 0x00020000
    s_mov_b32 s64, s24
    s_and_b32 s65, s25, 0xffff
    s_mov_b32 s66, 268435456
    s_mov_b32 s67, 0x00020000
    s_lshl2_add_u32 s92, s70, s68
    s_mul_i32 s93, s92, 3
    s_sub_u32 s93, 172, s93
    v_mov_b32 v113, 268435456
    v_add_u32 v110, 0, v0
    v_mul_u32_u24 v111, 43691, v110
    v_lshrrev_b32 v111, 17, v111
    v_mul_u32_u24 v112, 3, v111
    v_sub_u32 v112, v110, v112
    v_cmp_gt_i32 vcc, s93, v112
    v_and_b32 v118, 1, v111
    v_bfe_u32 v119, v111, 1, 3
    v_lshl_add_u32 v118, v118, 3, v119
    v_and_or_b32 v111, v111, 48, v118
    v_mul_u32_u24 v111, 2752, v111
    v_lshl_add_u32 v111, v112, 4, v111
    v_cndmask_b32 v123, v113, v111, vcc
    v_add_u32 v110, 64, v0
    v_mul_u32_u24 v111, 43691, v110
    v_lshrrev_b32 v111, 17, v111
    v_mul_u32_u24 v112, 3, v111
    v_sub_u32 v112, v110, v112
    v_cmp_gt_i32 vcc, s93, v112
    v_and_b32 v118, 1, v111
    v_bfe_u32 v119, v111, 1, 3
    v_lshl_add_u32 v118, v118, 3, v119
    v_and_or_b32 v111, v111, 48, v118
    v_mul_u32_u24 v111, 2752, v111
    v_lshl_add_u32 v111, v112, 4, v111
    v_subrev_u32 v111, 1024, v111
    v_cndmask_b32 v124, v113, v111, vcc
    v_add_u32 v110, 128, v0
    v_mul_u32_u24 v111, 43691, v110
    v_lshrrev_b32 v111, 17, v111
    v_mul_u32_u24 v112, 3, v111
    v_sub_u32 v112, v110, v112
    v_cmp_gt_i32 vcc, s93, v112
    v_and_b32 v118, 1, v111
    v_bfe_u32 v119, v111, 1, 3
    v_lshl_add_u32 v118, v118, 3, v119
    v_and_or_b32 v111, v111, 48, v118
    v_mul_u32_u24 v111, 2752, v111
    v_lshl_add_u32 v111, v112, 4, v111
    v_subrev_u32 v111, 2048, v111
    v_cndmask_b32 v125, v113, v111, vcc
    s_mul_i32 s92, s92, 48
    s_lshr_b32 s24, s69, 1
    s_add_u32 s24, s24, s70
    s_add_u32 s93, s24, 0
    s_and_b32 s93, s93, 3
    s_mul_i32 s93, s93, 352256
    s_add_u32 s4, s92, s93
    s_add_u32 s93, s24, 1
    s_and_b32 s93, s93, 3
    s_mul_i32 s93, s93, 352256
    s_add_u32 s5, s92, s93
    s_add_u32 s93, s24, 2
    s_and_b32 s93, s93, 3
    s_mul_i32 s93, s93, 352256
    s_add_u32 s6, s92, s93
    s_add_u32 s93, s24, 3
    s_and_b32 s93, s93, 3
    s_mul_i32 s93, s93, 352256
    s_add_u32 s7, s92, s93
    s_lshr_b32 s94, s70, 3
    s_lshl_b32 s94, s94, 4
    s_add_u32 s94, s94, s69
    s_and_b32 s95, s70, 7
    v_lshrrev_b32 v110, 3, v0
    v_and_b32 v111, 7, v0
    v_lshlrev_b32 v111, 4, v111
    v_lshl_add_u32 v110, v110, 10, v111
    s_lshl_b32 s92, s94, 2
    s_add_u32 s92, s92, s68
    s_lshl_b32 s96, s95, 7
    s_mul_i32 s93, s92, 12288
    s_add_u32 s93, s93, s96
    v_add_u32 v82, s93, v110
    v_add_u32 v83, 8192, v82
    s_lshl_b32 s93, s92, 12
    s_add_u32 s93, s93, s96
    v_add_u32 v84, s93, v110
    s_mul_i32 s13, s68, 1536
    s_lshl_b32 s14, s68, 9
    s_mul_i32 s8, s68, 3072
    s_lshl_b32 s15, s69, 14
    s_add_u32 s15, s15, 12713984
    s_and_b32 s92, s68, 1
    s_lshl4_add_u32 s92, s92, s70
    s_lshr_b32 s93, s68, 1
    s_lshl1_add_u32 s92, s92, s93
    s_lshl3_add_u32 s16, s92, s15
    s_lshl_b32 s92, s95, 2
    s_add_u32 s92, s92, s68
    s_lshl_b32 s25, s92, 14
    s_add_u32 s25, s25, 13107200
    s_mul_i32 s26, s95, 96
    s_mul_i32 s92, s68, 22
    s_add_u32 s26, s26, s92
    s_lshl_b32 s26, s26, 11
    s_add_u32 s26, s26, 13631488
    s_lshr_b32 s92, s70, 3
    s_lshl2_add_u32 s27, s69, s92
    s_and_b32 s92, s68, 1
    s_lshl_b32 s92, s92, 10
    v_xor_b32 v13, s92, v12
    v_xor_b32 v14, 1024, v13
    v_mov_b32 v109, 0x3f803f80
    s_movk_i32 s98, 12304
    v_bfe_u32 v110, v0, 2, 3
    v_lshrrev_b32 v111, 5, v0
    v_lshl_add_u32 v110, v111, 3, v110
    v_mul_u32_u24 v110, 96, v110
    v_add_u32 v110, s8, v110
    v_and_b32 v112, 3, v0
    v_lshl_add_u32 v108, v112, 3, v110
    v_bfe_u32 v112, v0, 1, 1
    v_lshl_add_u32 v110, v112, 3, v110
    v_and_b32 v113, 1, v0
    v_mad_u32_u24 v127, v113, s98, v110
    v_bfe_u32 v110, v0, 2, 2
    v_lshl_add_u32 v110, v111, 3, v110
    v_lshlrev_b32 v110, 7, v110
    v_bfe_u32 v113, v0, 4, 1
    v_lshl_add_u32 v110, v113, 5, v110
    v_and_b32 v112, 3, v0
    v_lshl_add_u32 v110, v112, 3, v110
    s_lshl1_add_u32 s96, s73, 148224
    v_add_u32 v88, s96, v110
    s_and_b32 s97, s68, 1
    s_lshl_b32 s96, s97, 6
    s_add_u32 s96, s96, 154368
    v_add_u32 v90, s96, v110
    s_cmp_eq_u32 s68, 3
    s_cselect_b32 s96, 268435456, 0
    v_or_b32 v89, s96, v12
    s_cmp_ge_u32 s68, 2
    s_cselect_b32 s96, 268435456, 0
    v_or_b32 v91, s96, v12
    s_lshl_b32 s92, s95, 5
    s_add_u32 s92, s92, s94
    s_mul_i32 s93, s92, 3
    s_add_u32 s93, s93, s68
    s_lshl_b32 s93, s93, 11
    s_add_u32 s10, s93, 13631488
    s_lshl_b32 s11, s92, 3
    s_add_u32 s11, s11, 12595200
    s_lshl1_add_u32 s92, s92, s97
    s_lshl_b32 s92, s92, 10
    s_add_u32 s12, s92, 13107200
    v_and_b32 v110, 31, v0
    v_lshrrev_b32 v111, 1, v110
    v_and_b32 v111, 7, v111
    v_lshrrev_b32 v112, 5, v0
    v_xor_b32 v111, v111, v112
    v_lshlrev_b32 v111, 4, v111
    v_lshl_add_u32 v111, v110, 7, v111
    s_lshl_b32 s96, s68, 12
    v_add_u32 v111, s96, v111
    v_lshlrev_b32 v113, 9, v112
    v_bfe_u32 v114, v0, 2, 2
    v_lshl_add_u32 v113, v114, 6, v113
    v_bfe_u32 v114, v0, 4, 1
    v_lshl_add_u32 v113, v114, 5, v113
    v_and_b32 v114, 3, v0
    v_lshl_add_u32 v57, v114, 3, v113
    s_add_u32 s97, s68, 0
    s_and_b32 s97, s97, 3
    s_lshl_b32 s98, s97, 5
    v_xor_b32 v4, s98, v111
    s_lshl_b32 s98, s97, 11
    s_add_u32 s98, s98, 16384
    v_add_u32 v8, s98, v57
    s_add_u32 s97, s68, 1
    s_and_b32 s97, s97, 3
    s_lshl_b32 s98, s97, 5
    v_xor_b32 v5, s98, v111
    s_lshl_b32 s98, s97, 11
    s_add_u32 s98, s98, 16384
    v_add_u32 v9, s98, v57
    s_add_u32 s97, s68, 2
    s_and_b32 s97, s97, 3
    s_lshl_b32 s98, s97, 5
    v_xor_b32 v6, s98, v111
    s_lshl_b32 s98, s97, 11
    s_add_u32 s98, s98, 16384
    v_add_u32 v10, s98, v57
    s_add_u32 s97, s68, 3
    s_and_b32 s97, s97, 3
    s_lshl_b32 s98, s97, 5
    v_xor_b32 v7, s98, v111
    s_lshl_b32 s98, s97, 11
    s_add_u32 s98, s98, 16384
    v_add_u32 v11, s98, v57
    v_mov_b32 v104, 0
    v_mov_b32 v105, 0
    v_mov_b32 v106, 0
    v_mov_b32 v107, 0
    v_add_u32 v15, 157440, v12
    s_lshl_b32 s92, s68, 2
    v_add_u32 v56, s92, v15
    v_and_b32 v122, 15, v0
    v_lshlrev_b32 v122, 3, v122
    v_and_b32 v110, 7, v0
    v_lshrrev_b32 v111, 1, v0
    v_and_b32 v111, 4, v111
    v_xor_b32 v110, v110, v111
    v_lshrrev_b32 v111, 5, v0
    v_lshlrev_b32 v111, 1, v111
    v_xor_b32 v110, v110, v111
    v_lshlrev_b32 v110, 4, v110
    v_and_b32 v111, 31, v0
    v_lshl_add_u32 v110, v111, 7, v110
    s_lshl2_add_u32 s92, s73, 49408
    v_add_u32 v48, s92, v110
    v_bfe_u32 v110, v0, 1, 2
    v_bfe_u32 v118, v0, 3, 1
    v_xor_b32 v110, v110, v118
    v_lshrrev_b32 v118, 5, v0
    v_lshlrev_b32 v118, 1, v118
    v_xor_b32 v110, v110, v118
    v_lshlrev_b32 v110, 4, v110
    v_lshl_add_u32 v110, v111, 6, v110
    s_lshl1_add_u32 s92, s73, 90496
    v_add_u32 v49, s92, v110
    s_and_b32 s92, s68, 1
    s_lshr_b32 s93, s68, 1
    s_lshl_b32 s94, s92, 2
    s_lshl_b32 s95, s93, 1
    s_add_u32 s94, s94, s95
    v_bfe_u32 v110, v0, 1, 1
    v_bfe_u32 v111, v0, 2, 2
    v_xor_b32 v110, v110, v111
    v_bfe_u32 v118, v0, 4, 1
    v_lshlrev_b32 v118, 2, v118
    v_xor_b32 v110, v110, v118
    v_xor_b32 v110, s94, v110
    v_lshlrev_b32 v110, 4, v110
    v_and_b32 v118, 1, v0
    v_lshl_add_u32 v110, v118, 3, v110
    v_lshrrev_b32 v118, 4, v0
    v_lshl_add_u32 v118, v118, 3, v111
    v_lshl_add_u32 v110, v118, 7, v110
    v_add_u32 v50, 49408, v110
    v_xor_b32 v110, 64, v110
    v_add_u32 v51, 49920, v110
    v_and_b32 v110, 1, v0
    v_lshlrev_b32 v110, 1, v110
    v_bfe_u32 v111, v0, 3, 1
    v_xor_b32 v110, v110, v111
    v_bfe_u32 v111, v0, 4, 1
    v_xor_b32 v110, v110, v111
    v_xor_b32 v110, s92, v110
    v_lshlrev_b32 v110, 4, v110
    v_bfe_u32 v111, v0, 1, 1
    v_lshl_add_u32 v110, v111, 3, v110
    v_lshl_add_u32 v110, v118, 6, v110
    v_add_u32 v52, 90496, v110
    v_xor_b32 v110, 32, v110
    v_add_u32 v53, 90752, v110
    v_mov_b32 v60, v109
    v_mov_b32 v61, v109
    v_mov_b32 v62, v109
    v_mov_b32 v63, v109
    v_and_b32 v110, 15, v0
    v_lshrrev_b32 v111, 4, v0
    v_lshlrev_b32 v111, 3, v111
    v_cmp_gt_u32 vcc, 4, v110
    v_lshl_add_u32 v54, v110, 5, v111
    v_add_u32 v111, 512, v54
    v_mov_b32 v118, 268435456
    v_cndmask_b32 v55, v118, v111, vcc
    s_add_u32 s77, s77, 8192
    s_lshl2_add_u32 m0, s73, 26752
    s_nop 0
    buffer_load_dwordx4 v1, s[28:31], s77 offen lds
    s_add_u32 s77, s77, 8192
    s_lshl2_add_u32 m0, s73, 27776
    s_nop 0
    buffer_load_dwordx4 v2, s[28:31], s77 offen lds
    s_lshl1_add_u32 m0, s73, 40064
    s_nop 0
    buffer_load_dwordx4 v3, s[32:35], s85 offen offset:1024 lds
    buffer_load_dwordx4 v3, s[32:35], s85 offen offset:2048 lds
    s_cmp_eq_u32 s68, 0
    s_cbranch_scc1 HS_2
    s_mov_b64 exec, 0
    s_cmp_eq_u32 s68, 1
    s_cbranch_scc1 HOP_1
    s_cmp_eq_u32 s68, 2
    s_cbranch_scc1 HOP_2
    s_branch HOP_3
HR_3:
    s_mov_b64 exec, -1
HS_2:
    s_waitcnt vmcnt(9)
    s_barrier
    ds_read_b128 v[128:131], v4 offset:0
    ds_read_b128 v[132:135], v5 offset:0
    ds_read_b128 v[136:139], v6 offset:0
    ds_read_b128 v[140:143], v7 offset:0
    ds_read_b64_tr_b16 v[64:65], v8 offset:0
    ds_read_b64_tr_b16 v[66:67], v8 offset:256
    ds_read_b64_tr_b16 v[68:69], v8 offset:1024
    ds_read_b64_tr_b16 v[70:71], v8 offset:1280
    ds_read_b64_tr_b16 a[8:9], v9 offset:0
    ds_read_b64_tr_b16 a[10:11], v9 offset:256
    ds_read_b64_tr_b16 a[12:13], v9 offset:1024
    ds_read_b64_tr_b16 a[14:15], v9 offset:1280
    ds_read_b64_tr_b16 a[16:17], v10 offset:0
    ds_read_b64_tr_b16 a[18:19], v10 offset:256
    ds_read_b64_tr_b16 a[20:21], v10 offset:1024
    ds_read_b64_tr_b16 a[22:23], v10 offset:1280
    ds_read_b64_tr_b16 a[24:25], v11 offset:0
    ds_read_b64_tr_b16 a[26:27], v11 offset:256
    ds_read_b64_tr_b16 a[28:29], v11 offset:1024
    ds_read_b64_tr_b16 a[30:31], v11 offset:1280
    s_waitcnt lgkmcnt(15)
    v_dot2c_f32_bf16 v104, v128, v109
    v_dot2c_f32_bf16 v105, v128, v128
    v_dot2c_f32_bf16 v104, v129, v109
    v_dot2c_f32_bf16 v105, v129, v129
    s_lshl2_add_u32 m0, s73, 49408
    s_nop 0
    buffer_load_dwordx4 v1, s[28:31], s78 offen lds
    v_dot2c_f32_bf16 v104, v130, v109
    v_dot2c_f32_bf16 v105, v130, v130
    v_dot2c_f32_bf16 v104, v131, v109
    s_add_u32 s78, s78, 8192
    s_lshl2_add_u32 m0, s73, 50432
    s_nop 0
    buffer_load_dwordx4 v2, s[28:31], s78 offen lds
    v_dot2c_f32_bf16 v105, v131, v131
    v_dot2c_f32_bf16 v104, v132, v109
    v_dot2c_f32_bf16 v105, v132, v132
    s_add_u32 s78, s78, 8192
    s_lshl2_add_u32 m0, s73, 51456
    s_nop 0
    buffer_load_dwordx4 v1, s[28:31], s78 offen lds
    v_dot2c_f32_bf16 v104, v133, v109
    v_dot2c_f32_bf16 v105, v133, v133
    v_dot2c_f32_bf16 v104, v134, v109
    v_dot2c_f32_bf16 v105, v134, v134
    s_add_u32 s78, s78, 8192
    s_lshl2_add_u32 m0, s73, 52480
    s_nop 0
    buffer_load_dwordx4 v2, s[28:31], s78 offen lds
    v_dot2c_f32_bf16 v104, v135, v109
    v_dot2c_f32_bf16 v105, v135, v135
    v_dot2c_f32_bf16 v104, v136, v109
    s_lshl1_add_u32 m0, s73, 64768
    s_nop 0
    buffer_load_dwordx4 v3, s[32:35], s86 offen offset:1024 lds
    v_dot2c_f32_bf16 v105, v136, v136
    v_dot2c_f32_bf16 v104, v137, v109
    v_dot2c_f32_bf16 v105, v137, v137
    buffer_load_dwordx4 v3, s[32:35], s86 offen offset:2048 lds
    v_dot2c_f32_bf16 v104, v138, v109
    v_dot2c_f32_bf16 v105, v138, v138
    v_dot2c_f32_bf16 v104, v139, v109
    v_dot2c_f32_bf16 v105, v139, v139
    s_lshl2_add_u32 m0, s73, 74112
    s_nop 0
    buffer_load_dwordx4 v1, s[28:31], s79 offen lds
    v_dot2c_f32_bf16 v104, v140, v109
    v_dot2c_f32_bf16 v105, v140, v140
    v_dot2c_f32_bf16 v104, v141, v109
    s_add_u32 s79, s79, 8192
    s_lshl2_add_u32 m0, s73, 75136
    s_nop 0
    buffer_load_dwordx4 v2, s[28:31], s79 offen lds
    v_dot2c_f32_bf16 v105, v141, v141
    v_dot2c_f32_bf16 v104, v142, v109
    v_dot2c_f32_bf16 v105, v142, v142
    s_add_u32 s79, s79, 8192
    s_lshl2_add_u32 m0, s73, 76160
    s_nop 0
    buffer_load_dwordx4 v1, s[28:31], s79 offen lds
    v_dot2c_f32_bf16 v104, v143, v109
    v_dot2c_f32_bf16 v105, v143, v143
    v_dot2c_f32_bf16 v106, v64, v109
    s_waitcnt lgkmcnt(13)
    v_dot2c_f32_bf16 v107, v68, v109
    s_add_u32 s79, s79, 8192
    s_lshl2_add_u32 m0, s73, 77184
    s_nop 0
    buffer_load_dwordx4 v2, s[28:31], s79 offen lds
    v_dot2c_f32_bf16 v106, v65, v109
    v_dot2c_f32_bf16 v107, v69, v109
    v_dot2c_f32_bf16 v106, v66, v109
    s_lshl1_add_u32 m0, s73, 89472
    s_nop 0
    buffer_load_dwordx4 v3, s[32:35], s87 offen offset:1024 lds
    s_waitcnt lgkmcnt(12)
    v_dot2c_f32_bf16 v107, v70, v109
    v_dot2c_f32_bf16 v106, v67, v109
    v_dot2c_f32_bf16 v107, v71, v109
    buffer_load_dwordx4 v3, s[32:35], s87 offen offset:2048 lds
    s_waitcnt vmcnt(12)
    s_waitcnt lgkmcnt(0)
    s_barrier
    v_mfma_f32_32x32x16_bf16 v[16:31], v[64:67], v[128:131], 0
    ds_read_b128 v[144:147], v4 offset:24704
    ds_read_b128 v[148:151], v5 offset:24704
    ds_read_b128 v[152:155], v6 offset:24704
    v_mfma_f32_32x32x16_bf16 v[32:47], v[68:71], v[128:131], 0
    ds_read_b128 v[156:159], v7 offset:24704
    ds_read_b64_tr_b16 v[72:73], v8 offset:24704
    ds_read_b64_tr_b16 v[74:75], v8 offset:24960
    v_mfma_f32_32x32x16_bf16 v[16:31], a[8:11], v[132:135], v[16:31]
    ds_read_b64_tr_b16 v[76:77], v8 offset:25728
    ds_read_b64_tr_b16 v[78:79], v8 offset:25984
    ds_read_b64_tr_b16 a[40:41], v9 offset:24704
    v_mfma_f32_32x32x16_bf16 v[32:47], a[12:15], v[132:135], v[32:47]
    ds_read_b64_tr_b16 a[42:43], v9 offset:24960
    s_lshl2_add_u32 m0, s73, 98816
    s_nop 0
    buffer_load_dwordx4 v1, s[28:31], s80 offen lds
    ds_read_b64_tr_b16 a[44:45], v9 offset:25728
    v_mfma_f32_32x32x16_bf16 v[16:31], a[16:19], v[136:139], v[16:31]
    ds_read_b64_tr_b16 a[46:47], v9 offset:25984
    ds_read_b64_tr_b16 a[48:49], v10 offset:24704
    ds_read_b64_tr_b16 a[50:51], v10 offset:24960
    v_mfma_f32_32x32x16_bf16 v[32:47], a[20:23], v[136:139], v[32:47]
    ds_read_b64_tr_b16 a[52:53], v10 offset:25728
    ds_read_b64_tr_b16 a[54:55], v10 offset:25984
    ds_read_b64_tr_b16 a[56:57], v11 offset:24704
    v_mfma_f32_32x32x16_bf16 v[16:31], a[24:27], v[140:143], v[16:31]
    ds_read_b64_tr_b16 a[58:59], v11 offset:24960
    ds_read_b64_tr_b16 a[60:61], v11 offset:25728
    ds_read_b64_tr_b16 a[62:63], v11 offset:25984
    s_add_u32 s80, s80, 8192
    s_lshl2_add_u32 m0, s73, 99840
    s_nop 0
    buffer_load_dwordx4 v2, s[28:31], s80 offen lds
    v_mfma_f32_32x32x16_bf16 v[32:47], a[28:31], v[140:143], v[32:47]
    v_lshrrev_b32 v110, 5, v0
    v_bfe_u32 v111, v0, 2, 2
    v_lshl_add_u32 v110, v110, 2, v111
    v_lshlrev_b32 v110, 5, v110
    v_bfe_u32 v111, v0, 4, 1
    v_lshl_add_u32 v110, v111, 4, v110
    v_bfe_u32 v111, v0, 1, 1
    v_lshl_add_u32 v110, v111, 3, v110
    v_add_u32 v110, 156416, v110
    ds_read_b64_tr_b16 v[96:97], v110 offset:0
    ds_read_b64_tr_b16 v[98:99], v110 offset:256
    ds_read_b64_tr_b16 v[100:101], v110 offset:512
    ds_read_b64_tr_b16 v[102:103], v110 offset:768
    v_bfe_u32 v110, v0, 2, 1
    v_mul_u32_u24 v110, 0x8000, v110
    v_lshl_add_u32 v110, v110, 16, v110
    s_waitcnt lgkmcnt(3)
    v_xor_b32 v96, v110, v96
    v_xor_b32 v97, v110, v97
    s_waitcnt lgkmcnt(2)
    v_xor_b32 v98, v110, v98
    v_xor_b32 v99, v110, v99
    s_waitcnt lgkmcnt(1)
    v_xor_b32 v100, v110, v100
    v_xor_b32 v101, v110, v101
    s_waitcnt lgkmcnt(0)
    v_xor_b32 v102, v110, v102
    v_xor_b32 v103, v110, v103
    v_dot2c_f32_bf16 v104, v144, v109
    v_dot2c_f32_bf16 v105, v144, v144
    v_dot2c_f32_bf16 v104, v145, v109
    v_dot2c_f32_bf16 v105, v145, v145
    v_dot2c_f32_bf16 v104, v146, v109
    v_dot2c_f32_bf16 v105, v146, v146
    v_dot2c_f32_bf16 v104, v147, v109
    v_dot2c_f32_bf16 v105, v147, v147
    v_dot2c_f32_bf16 v104, v148, v109
    v_dot2c_f32_bf16 v105, v148, v148
    v_dot2c_f32_bf16 v104, v149, v109
    v_dot2c_f32_bf16 v105, v149, v149
    v_dot2c_f32_bf16 v104, v150, v109
    v_dot2c_f32_bf16 v105, v150, v150
    v_dot2c_f32_bf16 v104, v151, v109
    v_dot2c_f32_bf16 v105, v151, v151
    v_dot2c_f32_bf16 v104, v152, v109
    v_dot2c_f32_bf16 v105, v152, v152
    v_dot2c_f32_bf16 v104, v153, v109
    v_dot2c_f32_bf16 v105, v153, v153
    s_add_u32 s80, s80, 8192
    s_lshl2_add_u32 m0, s73, 100864
    s_nop 0
    buffer_load_dwordx4 v1, s[28:31], s80 offen lds
    v_dot2c_f32_bf16 v104, v154, v109
    v_dot2c_f32_bf16 v105, v154, v154
    v_dot2c_f32_bf16 v104, v155, v109
    v_dot2c_f32_bf16 v105, v155, v155
    v_dot2c_f32_bf16 v104, v156, v109
    v_dot2c_f32_bf16 v105, v156, v156
    v_dot2c_f32_bf16 v104, v157, v109
    v_dot2c_f32_bf16 v105, v157, v157
    v_dot2c_f32_bf16 v104, v158, v109
    v_dot2c_f32_bf16 v105, v158, v158
    v_dot2c_f32_bf16 v104, v159, v109
    v_dot2c_f32_bf16 v105, v159, v159
    v_dot2c_f32_bf16 v106, v72, v109
    v_dot2c_f32_bf16 v107, v76, v109
    v_dot2c_f32_bf16 v106, v73, v109
    v_dot2c_f32_bf16 v107, v77, v109
    v_dot2c_f32_bf16 v106, v74, v109
    v_dot2c_f32_bf16 v107, v78, v109
    v_dot2c_f32_bf16 v106, v75, v109
    v_dot2c_f32_bf16 v107, v79, v109
    s_add_u32 s80, s80, 8192
    s_lshl2_add_u32 m0, s73, 101888
    s_nop 0
    buffer_load_dwordx4 v2, s[28:31], s80 offen lds
    s_waitcnt vmcnt(10)
    s_barrier
    v_mfma_f32_32x32x16_bf16 v[16:31], v[72:75], v[144:147], v[16:31]
    ds_read_b128 v[160:163], v4 offset:49408
    ds_read_b128 v[164:167], v5 offset:49408
    ds_read_b128 v[168:171], v6 offset:49408
    v_mfma_f32_32x32x16_bf16 v[32:47], v[76:79], v[144:147], v[32:47]
    ds_read_b128 v[172:175], v7 offset:49408
    ds_read_b64_tr_b16 v[64:65], v8 offset:49408
    s_lshl1_add_u32 m0, s73, 114176
    s_nop 0
    buffer_load_dwordx4 v3, s[32:35], s88 offen offset:1024 lds
    v_mfma_f32_32x32x16_bf16 v[16:31], a[40:43], v[148:151], v[16:31]
    ds_read_b64_tr_b16 v[66:67], v8 offset:49664
HOP_1:
    s_cbranch_execz HR_3
    ds_read_b64_tr_b16 v[68:69], v8 offset:50432
    ds_read_b64_tr_b16 v[70:71], v8 offset:50688
    ds_read_b64_tr_b16 a[8:9], v9 offset:49408
    v_mfma_f32_32x32x16_bf16 v[32:47], a[44:47], v[148:151], v[32:47]
    ds_read_b64_tr_b16 a[10:11], v9 offset:49664
    buffer_load_dwordx4 v3, s[32:35], s88 offen offset:2048 lds
    ds_read_b64_tr_b16 a[12:13], v9 offset:50432
    v_mfma_f32_32x32x16_bf16 v[16:31], a[48:51], v[152:155], v[16:31]
    ds_read_b64_tr_b16 a[14:15], v9 offset:50688
    ds_read_b64_tr_b16 a[16:17], v10 offset:49408
    ds_read_b64_tr_b16 a[18:19], v10 offset:49664
    ds_read_b64_tr_b16 a[20:21], v10 offset:50432
    v_mfma_f32_32x32x16_bf16 v[32:47], a[52:55], v[152:155], v[32:47]
    s_lshl2_add_u32 m0, s73, 0
    s_nop 0
    buffer_load_dwordx4 v1, s[28:31], s81 offen lds
    ds_read_b64_tr_b16 a[22:23], v10 offset:50688
    ds_read_b64_tr_b16 a[24:25], v11 offset:49408
    v_mfma_f32_32x32x16_bf16 v[16:31], a[56:59], v[156:159], v[16:31]
    ds_read_b64_tr_b16 a[26:27], v11 offset:49664
    ds_read_b64_tr_b16 a[28:29], v11 offset:50432
    ds_read_b64_tr_b16 a[30:31], v11 offset:50688
    s_add_u32 s81, s81, 8192
    s_lshl2_add_u32 m0, s73, 1024
    s_nop 0
    buffer_load_dwordx4 v2, s[28:31], s81 offen lds
    v_mfma_f32_32x32x16_bf16 v[32:47], a[60:63], v[156:159], v[32:47]
    s_waitcnt lgkmcnt(15)
    v_dot2c_f32_bf16 v104, v160, v109
    v_dot2c_f32_bf16 v105, v160, v160
    v_dot2c_f32_bf16 v104, v161, v109
    v_dot2c_f32_bf16 v105, v161, v161
    v_dot2c_f32_bf16 v104, v162, v109
    v_dot2c_f32_bf16 v105, v162, v162
    v_dot2c_f32_bf16 v104, v163, v109
    v_dot2c_f32_bf16 v105, v163, v163
    v_dot2c_f32_bf16 v104, v164, v109
    v_dot2c_f32_bf16 v105, v164, v164
    v_dot2c_f32_bf16 v104, v165, v109
    v_dot2c_f32_bf16 v105, v165, v165
    s_add_u32 s81, s81, 8192
    s_lshl2_add_u32 m0, s73, 2048
    s_nop 0
    buffer_load_dwordx4 v1, s[28:31], s81 offen lds
    v_dot2c_f32_bf16 v104, v166, v109
    v_dot2c_f32_bf16 v105, v166, v166
    v_dot2c_f32_bf16 v104, v167, v109
    v_dot2c_f32_bf16 v105, v167, v167
    v_dot2c_f32_bf16 v104, v168, v109
    v_dot2c_f32_bf16 v105, v168, v168
    v_dot2c_f32_bf16 v104, v169, v109
    v_dot2c_f32_bf16 v105, v169, v169
    v_dot2c_f32_bf16 v104, v170, v109
    v_dot2c_f32_bf16 v105, v170, v170
    v_dot2c_f32_bf16 v104, v171, v109
    v_dot2c_f32_bf16 v105, v171, v171
    s_add_u32 s81, s81, 8192
    s_lshl2_add_u32 m0, s73, 3072
    s_nop 0
    buffer_load_dwordx4 v2, s[28:31], s81 offen lds
    v_dot2c_f32_bf16 v104, v172, v109
    v_dot2c_f32_bf16 v105, v172, v172
    v_dot2c_f32_bf16 v104, v173, v109
    v_dot2c_f32_bf16 v105, v173, v173
    v_dot2c_f32_bf16 v104, v174, v109
    v_dot2c_f32_bf16 v105, v174, v174
    v_dot2c_f32_bf16 v104, v175, v109
    v_dot2c_f32_bf16 v105, v175, v175
    v_dot2c_f32_bf16 v106, v64, v109
    s_waitcnt lgkmcnt(13)
    v_dot2c_f32_bf16 v107, v68, v109
    v_dot2c_f32_bf16 v106, v65, v109
    v_dot2c_f32_bf16 v107, v69, v109
    s_lshl1_add_u32 m0, s73, 15360
    s_nop 0
    buffer_load_dwordx4 v3, s[32:35], s89 offen offset:1024 lds
    v_dot2c_f32_bf16 v106, v66, v109
    s_waitcnt lgkmcnt(12)
    v_dot2c_f32_bf16 v107, v70, v109
    v_dot2c_f32_bf16 v106, v67, v109
    v_dot2c_f32_bf16 v107, v71, v109
    v_add_u32 v4, 74112, v4
    v_add_u32 v5, 74112, v5
    v_add_u32 v6, 74112, v6
    v_add_u32 v7, 74112, v7
    v_add_u32 v8, 74112, v8
    v_add_u32 v9, 74112, v9
    v_add_u32 v10, 74112, v10
    v_add_u32 v11, 74112, v11
    buffer_load_dwordx4 v3, s[32:35], s89 offen offset:2048 lds
    s_waitcnt vmcnt(12)
    s_waitcnt lgkmcnt(0)
    s_barrier
    v_mfma_f32_32x32x16_bf16 v[16:31], v[64:67], v[160:163], v[16:31]
    ds_read_b128 v[176:179], v4 offset:0
    ds_read_b128 v[180:183], v5 offset:0
    ds_read_b128 v[184:187], v6 offset:0
    v_mfma_f32_32x32x16_bf16 v[32:47], v[68:71], v[160:163], v[32:47]
    ds_read_b128 v[188:191], v7 offset:0
    ds_read_b64_tr_b16 v[72:73], v8 offset:0
    s_lshl2_add_u32 m0, s73, 24704
    s_nop 0
    buffer_load_dwordx4 v1, s[28:31], s82 offen lds
    v_mfma_f32_32x32x16_bf16 v[16:31], a[8:11], v[164:167], v[16:31]
    ds_read_b64_tr_b16 v[74:75], v8 offset:256
    ds_read_b64_tr_b16 v[76:77], v8 offset:1024
    ds_read_b64_tr_b16 v[78:79], v8 offset:1280
    ds_read_b64_tr_b16 a[40:41], v9 offset:0
    v_mfma_f32_32x32x16_bf16 v[32:47], a[12:15], v[164:167], v[32:47]
    ds_read_b64_tr_b16 a[42:43], v9 offset:256
    s_add_u32 s82, s82, 8192
    s_lshl2_add_u32 m0, s73, 25728
    s_nop 0
    buffer_load_dwordx4 v2, s[28:31], s82 offen lds
    ds_read_b64_tr_b16 a[44:45], v9 offset:1024
    v_mfma_f32_32x32x16_bf16 v[16:31], a[16:19], v[168:171], v[16:31]
    ds_read_b64_tr_b16 a[46:47], v9 offset:1280
    ds_read_b64_tr_b16 a[48:49], v10 offset:0
    ds_read_b64_tr_b16 a[50:51], v10 offset:256
    ds_read_b64_tr_b16 a[52:53], v10 offset:1024
    v_mfma_f32_32x32x16_bf16 v[32:47], a[20:23], v[168:171], v[32:47]
    s_add_u32 s82, s82, 8192
    s_lshl2_add_u32 m0, s73, 26752
    s_nop 0
    buffer_load_dwordx4 v1, s[28:31], s82 offen lds
    ds_read_b64_tr_b16 a[54:55], v10 offset:1280
    ds_read_b64_tr_b16 a[56:57], v11 offset:0
    v_mfma_f32_32x32x16_bf16 v[16:31], a[24:27], v[172:175], v[16:31]
    ds_read_b64_tr_b16 a[58:59], v11 offset:256
    ds_read_b64_tr_b16 a[60:61], v11 offset:1024
    ds_read_b64_tr_b16 a[62:63], v11 offset:1280
    s_add_u32 s82, s82, 8192
    s_lshl2_add_u32 m0, s73, 27776
    s_nop 0
    buffer_load_dwordx4 v2, s[28:31], s82 offen lds
    v_mfma_f32_32x32x16_bf16 v[32:47], a[28:31], v[172:175], v[32:47]
    s_waitcnt lgkmcnt(15)
    v_dot2c_f32_bf16 v104, v176, v109
    v_dot2c_f32_bf16 v105, v176, v176
    v_dot2c_f32_bf16 v104, v177, v109
    v_dot2c_f32_bf16 v105, v177, v177
    v_dot2c_f32_bf16 v104, v178, v109
    v_dot2c_f32_bf16 v105, v178, v178
    v_dot2c_f32_bf16 v104, v179, v109
    v_dot2c_f32_bf16 v105, v179, v179
    v_dot2c_f32_bf16 v104, v180, v109
    v_dot2c_f32_bf16 v105, v180, v180
    s_lshl1_add_u32 m0, s73, 40064
    s_nop 0
    buffer_load_dwordx4 v3, s[32:35], s90 offen offset:1024 lds
    v_dot2c_f32_bf16 v104, v181, v109
    v_dot2c_f32_bf16 v105, v181, v181
    v_dot2c_f32_bf16 v104, v182, v109
    v_dot2c_f32_bf16 v105, v182, v182
    v_dot2c_f32_bf16 v104, v183, v109
    v_dot2c_f32_bf16 v105, v183, v183
    v_dot2c_f32_bf16 v104, v184, v109
    v_dot2c_f32_bf16 v105, v184, v184
    v_dot2c_f32_bf16 v104, v185, v109
    v_dot2c_f32_bf16 v105, v185, v185
    buffer_load_dwordx4 v3, s[32:35], s90 offen offset:2048 lds
    v_dot2c_f32_bf16 v104, v186, v109
    v_dot2c_f32_bf16 v105, v186, v186
    v_dot2c_f32_bf16 v104, v187, v109
    v_dot2c_f32_bf16 v105, v187, v187
    v_dot2c_f32_bf16 v104, v188, v109
    v_dot2c_f32_bf16 v105, v188, v188
    v_dot2c_f32_bf16 v104, v189, v109
    v_dot2c_f32_bf16 v105, v189, v189
    v_dot2c_f32_bf16 v104, v190, v109
    v_dot2c_f32_bf16 v105, v190, v190
    s_lshl2_add_u32 m0, s73, 49408
    s_nop 0
    buffer_load_dwordx4 v1, s[28:31], s83 offen lds
    v_dot2c_f32_bf16 v104, v191, v109
    v_dot2c_f32_bf16 v105, v191, v191
    v_dot2c_f32_bf16 v106, v72, v109
    s_waitcnt lgkmcnt(13)
    v_dot2c_f32_bf16 v107, v76, v109
    v_dot2c_f32_bf16 v106, v73, v109
    v_dot2c_f32_bf16 v107, v77, v109
    v_dot2c_f32_bf16 v106, v74, v109
    s_waitcnt lgkmcnt(12)
    v_dot2c_f32_bf16 v107, v78, v109
    v_dot2c_f32_bf16 v106, v75, v109
    v_dot2c_f32_bf16 v107, v79, v109
    s_add_u32 s83, s83, 8192
    s_lshl2_add_u32 m0, s73, 50432
    s_nop 0
    buffer_load_dwordx4 v2, s[28:31], s83 offen lds
    s_waitcnt vmcnt(14)
    s_waitcnt lgkmcnt(0)
    s_barrier
    v_mfma_f32_32x32x16_bf16 v[16:31], v[72:75], v[176:179], v[16:31]
    ds_read_b128 v[192:195], v4 offset:24704
    ds_read_b128 v[196:199], v5 offset:24704
    ds_read_b128 v[200:203], v6 offset:24704
    v_mfma_f32_32x32x16_bf16 v[32:47], v[76:79], v[176:179], v[32:47]
    ds_read_b128 v[204:207], v7 offset:24704
    s_add_u32 s83, s83, 8192
    s_lshl2_add_u32 m0, s73, 51456
    s_nop 0
    buffer_load_dwordx4 v1, s[28:31], s83 offen lds
    ds_read_b64_tr_b16 v[64:65], v8 offset:24704
    ds_read_b64_tr_b16 v[66:67], v8 offset:24960
    v_mfma_f32_32x32x16_bf16 v[16:31], a[40:43], v[180:183], v[16:31]
    ds_read_b64_tr_b16 v[68:69], v8 offset:25728
    ds_read_b64_tr_b16 v[70:71], v8 offset:25984
    s_add_u32 s83, s83, 8192
    s_lshl2_add_u32 m0, s73, 52480
    s_nop 0
    buffer_load_dwordx4 v2, s[28:31], s83 offen lds
    v_mfma_f32_32x32x16_bf16 v[32:47], a[44:47], v[180:183], v[32:47]
    ds_read_b64_tr_b16 a[8:9], v9 offset:24704
    ds_read_b64_tr_b16 a[10:11], v9 offset:24960
    ds_read_b64_tr_b16 a[12:13], v9 offset:25728
    ds_read_b64_tr_b16 a[14:15], v9 offset:25984
    v_mfma_f32_32x32x16_bf16 v[16:31], a[48:51], v[184:187], v[16:31]
    s_lshl1_add_u32 m0, s73, 64768
    s_nop 0
    buffer_load_dwordx4 v3, s[32:35], s91 offen offset:1024 lds
    ds_read_b64_tr_b16 a[16:17], v10 offset:24704
    ds_read_b64_tr_b16 a[18:19], v10 offset:24960
    v_mfma_f32_32x32x16_bf16 v[32:47], a[52:55], v[184:187], v[32:47]
    ds_read_b64_tr_b16 a[20:21], v10 offset:25728
    ds_read_b64_tr_b16 a[22:23], v10 offset:25984
    buffer_load_dwordx4 v3, s[32:35], s91 offen offset:2048 lds
    ds_read_b64_tr_b16 a[24:25], v11 offset:24704
    v_mfma_f32_32x32x16_bf16 v[16:31], a[56:59], v[188:191], v[16:31]
    ds_read_b64_tr_b16 a[26:27], v11 offset:24960
    ds_read_b64_tr_b16 a[28:29], v11 offset:25728
    ds_read_b64_tr_b16 a[30:31], v11 offset:25984
    s_add_u32 m0, s14, 154368
    s_mov_b32 exec_hi, 0
    buffer_load_dwordx4 v84, s[40:43], 0 offen lds
    s_mov_b32 exec_hi, -1
    v_mfma_f32_32x32x16_bf16 v[32:47], a[60:63], v[188:191], v[32:47]
    s_waitcnt lgkmcnt(15)
    v_dot2c_f32_bf16 v104, v192, v109
    v_dot2c_f32_bf16 v105, v192, v192
    v_dot2c_f32_bf16 v104, v193, v109
    v_dot2c_f32_bf16 v105, v193, v193
    v_dot2c_f32_bf16 v104, v194, v109
    v_dot2c_f32_bf16 v105, v194, v194
    v_dot2c_f32_bf16 v104, v195, v109
    v_dot2c_f32_bf16 v105, v195, v195
    v_dot2c_f32_bf16 v104, v196, v109
    v_dot2c_f32_bf16 v105, v196, v196
    v_dot2c_f32_bf16 v104, v197, v109
    v_dot2c_f32_bf16 v105, v197, v197
    v_dot2c_f32_bf16 v104, v198, v109
    v_dot2c_f32_bf16 v105, v198, v198
    v_dot2c_f32_bf16 v104, v199, v109
    v_dot2c_f32_bf16 v105, v199, v199
    v_dot2c_f32_bf16 v104, v200, v109
    v_dot2c_f32_bf16 v105, v200, v200
    v_dot2c_f32_bf16 v104, v201, v109
    v_dot2c_f32_bf16 v105, v201, v201
    v_dot2c_f32_bf16 v104, v202, v109
    v_dot2c_f32_bf16 v105, v202, v202
    v_dot2c_f32_bf16 v104, v203, v109
    v_dot2c_f32_bf16 v105, v203, v203
    v_dot2c_f32_bf16 v104, v204, v109
    v_dot2c_f32_bf16 v105, v204, v204
    v_dot2c_f32_bf16 v104, v205, v109
    v_dot2c_f32_bf16 v105, v205, v205
    v_dot2c_f32_bf16 v104, v206, v109
    v_dot2c_f32_bf16 v105, v206, v206
    v_dot2c_f32_bf16 v104, v207, v109
    v_dot2c_f32_bf16 v105, v207, v207
    v_dot2c_f32_bf16 v106, v64, v109
    s_waitcnt lgkmcnt(13)
    v_dot2c_f32_bf16 v107, v68, v109
    v_dot2c_f32_bf16 v106, v65, v109
    v_dot2c_f32_bf16 v107, v69, v109
    v_dot2c_f32_bf16 v106, v66, v109
    s_waitcnt lgkmcnt(12)
    v_dot2c_f32_bf16 v107, v70, v109
    v_dot2c_f32_bf16 v106, v67, v109
    v_dot2c_f32_bf16 v107, v71, v109
    v_add_u32 v4, -74112, v4
    v_add_u32 v5, -74112, v5
    v_add_u32 v6, -74112, v6
    v_add_u32 v7, -74112, v7
    v_add_u32 v8, -74112, v8
    v_add_u32 v9, -74112, v9
    v_add_u32 v10, -74112, v10
    v_add_u32 v11, -74112, v11
    v_lshlrev_b32 v114, 7, v0
    s_lshl2_add_u32 s71, s2, s68
    s_mul_i32 s71, s71, 1376
    s_mov_b64 exec, 2047
    buffer_load_dword a250, v114, s[44:47], s71 offen
    buffer_load_dword a251, v114, s[48:51], s71 offen
    s_mov_b64 exec, -1
    s_waitcnt vmcnt(15)
    s_waitcnt lgkmcnt(0)
    s_barrier
    v_mfma_f32_32x32x16_bf16 v[16:31], v[64:67], v[192:195], v[16:31]
    ds_read_b128 v[208:211], v4 offset:0
    ds_read_b128 v[212:215], v5 offset:0
    ds_read_b128 v[216:219], v6 offset:0
    v_mfma_f32_32x32x16_bf16 v[32:47], v[68:71], v[192:195], v[32:47]
    ds_read_b128 v[220:223], v7 offset:0
    ds_read_b64_tr_b16 v[72:73], v8 offset:0
    s_mov_b64 exec, 1
    buffer_load_dwordx2 v[120:121], v12, s[60:63], 0 offen sc1
    s_mov_b64 exec, -1
    v_mfma_f32_32x32x16_bf16 v[16:31], a[8:11], v[196:199], v[16:31]
    ds_read_b64_tr_b16 v[74:75], v8 offset:256
    ds_read_b64_tr_b16 v[76:77], v8 offset:1024
    ds_read_b64_tr_b16 v[78:79], v8 offset:1280
    ds_read_b64_tr_b16 a[40:41], v9 offset:0
    v_mfma_f32_32x32x16_bf16 v[32:47], a[12:15], v[196:199], v[32:47]
    ds_read_b64_tr_b16 a[42:43], v9 offset:256
    v_lshlrev_b32 v114, 7, v0
    s_lshl_b32 s71, s69, 11
    s_add_u32 s71, s71, 13008896
    s_lshr_b32 s3, s2, 5
    s_cmp_eq_u32 s3, 7
    s_cselect_b64 exec, 0, 0xfff
    buffer_load_dword a252, v114, s[64:67], s71 offen
    s_mov_b64 exec, -1
    ds_read_b64_tr_b16 a[44:45], v9 offset:1024
    v_mfma_f32_32x32x16_bf16 v[16:31], a[16:19], v[200:203], v[16:31]
    ds_read_b64_tr_b16 a[46:47], v9 offset:1280
    ds_read_b64_tr_b16 a[48:49], v10 offset:0
    ds_read_b64_tr_b16 a[50:51], v10 offset:256
    ds_read_b64_tr_b16 a[52:53], v10 offset:1024
    v_mfma_f32_32x32x16_bf16 v[32:47], a[20:23], v[200:203], v[32:47]
    v_lshlrev_b32 v114, 9, v0
    s_lshl3_add_u32 s71, s70, s68
    s_lshl_b32 s71, s71, 7
    s_add_u32 s71, s71, s15
    s_mov_b64 exec, 3
    buffer_load_dword a254, v114, s[64:67], s71 offen
    s_mov_b64 exec, -1
    ds_read_b64_tr_b16 a[54:55], v10 offset:1280
    ds_read_b64_tr_b16 a[56:57], v11 offset:0
    v_mfma_f32_32x32x16_bf16 v[16:31], a[24:27], v[204:207], v[16:31]
    ds_read_b64_tr_b16 a[58:59], v11 offset:256
    ds_read_b64_tr_b16 a[60:61], v11 offset:1024
    ds_read_b64_tr_b16 a[62:63], v11 offset:1280
    s_lshl_b32 s71, s70, 7
    s_add_u32 s71, s71, 12582912
    v_mov_b32 v114, s71
    v_writelane_b32 v114, s11, 1
    s_add_u32 s71, s11, 10240
    v_writelane_b32 v114, s71, 2
    s_mov_b64 exec, 7
    buffer_load_dword a253, v114, s[64:67], 0 offen sc1
    s_mov_b64 exec, -1
    v_mfma_f32_32x32x16_bf16 v[32:47], a[28:31], v[204:207], v[32:47]
    s_waitcnt lgkmcnt(15)
    v_dot2c_f32_bf16 v104, v208, v109
    v_dot2c_f32_bf16 v105, v208, v208
    v_dot2c_f32_bf16 v104, v209, v109
    v_dot2c_f32_bf16 v105, v209, v209
    v_dot2c_f32_bf16 v104, v210, v109
    v_dot2c_f32_bf16 v105, v210, v210
    v_dot2c_f32_bf16 v104, v211, v109
    v_dot2c_f32_bf16 v105, v211, v211
    v_dot2c_f32_bf16 v104, v212, v109
    v_dot2c_f32_bf16 v105, v212, v212
    v_dot2c_f32_bf16 v104, v213, v109
    v_dot2c_f32_bf16 v105, v213, v213
    v_dot2c_f32_bf16 v104, v214, v109
    v_dot2c_f32_bf16 v105, v214, v214
    v_dot2c_f32_bf16 v104, v215, v109
    v_dot2c_f32_bf16 v105, v215, v215
    v_dot2c_f32_bf16 v104, v216, v109
    v_dot2c_f32_bf16 v105, v216, v216
    v_dot2c_f32_bf16 v104, v217, v109
    v_dot2c_f32_bf16 v105, v217, v217
    s_lshl2_add_u32 m0, s73, 75136
    s_nop 0
    buffer_load_dwordx4 v3, s[32:35], s85 offen lds
    v_dot2c_f32_bf16 v104, v218, v109
    v_dot2c_f32_bf16 v105, v218, v218
    v_dot2c_f32_bf16 v104, v219, v109
    v_dot2c_f32_bf16 v105, v219, v219
    v_dot2c_f32_bf16 v104, v220, v109
    v_dot2c_f32_bf16 v105, v220, v220
    v_dot2c_f32_bf16 v104, v221, v109
    v_dot2c_f32_bf16 v105, v221, v221
    v_dot2c_f32_bf16 v104, v222, v109
    v_dot2c_f32_bf16 v105, v222, v222
    v_dot2c_f32_bf16 v104, v223, v109
    v_dot2c_f32_bf16 v105, v223, v223
    v_dot2c_f32_bf16 v106, v72, v109
    s_waitcnt lgkmcnt(13)
    v_dot2c_f32_bf16 v107, v76, v109
    v_dot2c_f32_bf16 v106, v73, v109
    v_dot2c_f32_bf16 v107, v77, v109
    v_dot2c_f32_bf16 v106, v74, v109
    s_waitcnt lgkmcnt(12)
    v_dot2c_f32_bf16 v107, v78, v109
    v_dot2c_f32_bf16 v106, v75, v109
    v_dot2c_f32_bf16 v107, v79, v109
    s_lshl2_add_u32 m0, s73, 76160
    s_nop 0
    buffer_load_dwordx4 v3, s[32:35], s86 offen lds
    s_waitcnt vmcnt(8)
    s_waitcnt lgkmcnt(0)
    s_barrier
    v_mfma_f32_32x32x16_bf16 v[16:31], v[72:75], v[208:211], v[16:31]
    ds_read_b128 v[224:227], v4 offset:24704
    ds_read_b128 v[228:231], v5 offset:24704
    ds_read_b128 v[232:235], v6 offset:24704
    v_mfma_f32_32x32x16_bf16 v[32:47], v[76:79], v[208:211], v[32:47]
    ds_read_b128 v[236:239], v7 offset:24704
    ds_read_b64_tr_b16 v[64:65], v8 offset:24704
    ds_read_b64_tr_b16 v[66:67], v8 offset:24960
    v_mfma_f32_32x32x16_bf16 v[16:31], a[40:43], v[212:215], v[16:31]
    ds_read_b64_tr_b16 v[68:69], v8 offset:25728
    ds_read_b64_tr_b16 v[70:71], v8 offset:25984
    ds_read_b64_tr_b16 a[8:9], v9 offset:24704
    v_mfma_f32_32x32x16_bf16 v[32:47], a[44:47], v[212:215], v[32:47]
    ds_read_b64_tr_b16 a[10:11], v9 offset:24960
    ds_read_b64_tr_b16 a[12:13], v9 offset:25728
    ds_read_b64_tr_b16 a[14:15], v9 offset:25984
    v_mfma_f32_32x32x16_bf16 v[16:31], a[48:51], v[216:219], v[16:31]
    ds_read_b64_tr_b16 a[16:17], v10 offset:24704
    ds_read_b64_tr_b16 a[18:19], v10 offset:24960
    ds_read_b64_tr_b16 a[20:21], v10 offset:25728
    v_mfma_f32_32x32x16_bf16 v[32:47], a[52:55], v[216:219], v[32:47]
    ds_read_b64_tr_b16 a[22:23], v10 offset:25984
    ds_read_b64_tr_b16 a[24:25], v11 offset:24704
    ds_read_b64_tr_b16 a[26:27], v11 offset:24960
    v_mfma_f32_32x32x16_bf16 v[16:31], a[56:59], v[220:223], v[16:31]
    ds_read_b64_tr_b16 a[28:29], v11 offset:25728
    ds_read_b64_tr_b16 a[30:31], v11 offset:25984
    ds_read_b64_tr_b16 a[192:193], v90
    ds_read_b64_tr_b16 a[194:195], v90 offset:512
    v_mfma_f32_32x32x16_bf16 v[32:47], a[60:63], v[220:223], v[32:47]
    s_waitcnt lgkmcnt(15)
    v_dot2c_f32_bf16 v104, v224, v109
    v_dot2c_f32_bf16 v105, v224, v224
    v_dot2c_f32_bf16 v104, v225, v109
    v_dot2c_f32_bf16 v105, v225, v225
    v_dot2c_f32_bf16 v104, v226, v109
    v_dot2c_f32_bf16 v105, v226, v226
    v_dot2c_f32_bf16 v104, v227, v109
    v_dot2c_f32_bf16 v105, v227, v227
    v_dot2c_f32_bf16 v104, v228, v109
    v_dot2c_f32_bf16 v105, v228, v228
    v_dot2c_f32_bf16 v104, v229, v109
    v_dot2c_f32_bf16 v105, v229, v229
    v_dot2c_f32_bf16 v104, v230, v109
    v_dot2c_f32_bf16 v105, v230, v230
    v_dot2c_f32_bf16 v104, v231, v109
    v_dot2c_f32_bf16 v105, v231, v231
    v_dot2c_f32_bf16 v104, v232, v109
    v_dot2c_f32_bf16 v105, v232, v232
    v_dot2c_f32_bf16 v104, v233, v109
    v_dot2c_f32_bf16 v105, v233, v233
    v_dot2c_f32_bf16 v104, v234, v109
    v_dot2c_f32_bf16 v105, v234, v234
    v_dot2c_f32_bf16 v104, v235, v109
    v_dot2c_f32_bf16 v105, v235, v235
    s_waitcnt lgkmcnt(0)
    buffer_store_dwordx4 a[192:195], v91, s[64:67], s12 offen sc1
    v_dot2c_f32_bf16 v104, v236, v109
    v_dot2c_f32_bf16 v105, v236, v236
    v_dot2c_f32_bf16 v104, v237, v109
    v_dot2c_f32_bf16 v105, v237, v237
    v_dot2c_f32_bf16 v104, v238, v109
    v_dot2c_f32_bf16 v105, v238, v238
    v_dot2c_f32_bf16 v104, v239, v109
    v_dot2c_f32_bf16 v105, v239, v239
    v_dot2c_f32_bf16 v106, v64, v109
    v_dot2c_f32_bf16 v107, v68, v109
    v_dot2c_f32_bf16 v106, v65, v109
    v_dot2c_f32_bf16 v107, v69, v109
    v_dot2c_f32_bf16 v106, v66, v109
    v_dot2c_f32_bf16 v107, v70, v109
    v_dot2c_f32_bf16 v106, v67, v109
    v_dot2c_f32_bf16 v107, v71, v109
    s_lshl2_add_u32 m0, s73, 74112
    s_nop 0
    buffer_load_dwordx4 v3, s[32:35], s84 offen lds
    s_barrier
    v_mfma_f32_32x32x16_bf16 v[16:31], v[64:67], v[224:227], v[16:31]
    ds_read_b128 v[240:243], v4 offset:49408
    ds_read_b128 v[244:247], v5 offset:49408
    v_mfma_f32_32x32x16_bf16 v[32:47], v[68:71], v[224:227], v[32:47]
    ds_read_b128 v[248:251], v6 offset:49408
    ds_read_b128 v[252:255], v7 offset:49408
    ds_read_b64_tr_b16 v[72:73], v8 offset:49408
    v_mfma_f32_32x32x16_bf16 v[16:31], a[8:11], v[228:231], v[16:31]
    ds_read_b64_tr_b16 v[74:75], v8 offset:49664
    ds_read_b64_tr_b16 v[76:77], v8 offset:50432
    ds_read_b64_tr_b16 v[78:79], v8 offset:50688
    v_mfma_f32_32x32x16_bf16 v[32:47], a[12:15], v[228:231], v[32:47]
    ds_read_b64_tr_b16 a[40:41], v9 offset:49408
    ds_read_b64_tr_b16 a[42:43], v9 offset:49664
    ds_read_b64_tr_b16 a[44:45], v9 offset:50432
    v_mfma_f32_32x32x16_bf16 v[16:31], a[16:19], v[232:235], v[16:31]
    ds_read_b64_tr_b16 a[46:47], v9 offset:50688
    ds_read_b64_tr_b16 a[48:49], v10 offset:49408
    ds_read_b64_tr_b16 a[50:51], v10 offset:49664
    v_mfma_f32_32x32x16_bf16 v[32:47], a[20:23], v[232:235], v[32:47]
    ds_read_b64_tr_b16 a[52:53], v10 offset:50432
    ds_read_b64_tr_b16 a[54:55], v10 offset:50688
    ds_read_b64_tr_b16 a[56:57], v11 offset:49408
    v_mfma_f32_32x32x16_bf16 v[16:31], a[24:27], v[236:239], v[16:31]
    ds_read_b64_tr_b16 a[58:59], v11 offset:49664
    ds_read_b64_tr_b16 a[60:61], v11 offset:50432
    ds_read_b64_tr_b16 a[62:63], v11 offset:50688
    v_mfma_f32_32x32x16_bf16 v[32:47], a[28:31], v[236:239], v[32:47]
    s_waitcnt lgkmcnt(15)
    v_dot2c_f32_bf16 v106, v72, v109
    s_waitcnt lgkmcnt(13)
    v_dot2c_f32_bf16 v107, v76, v109
    v_dot2c_f32_bf16 v106, v73, v109
    v_dot2c_f32_bf16 v107, v77, v109
    v_dot2c_f32_bf16 v106, v74, v109
    s_waitcnt lgkmcnt(12)
    v_dot2c_f32_bf16 v107, v78, v109
    v_dot2c_f32_bf16 v106, v75, v109
    v_dot2c_f32_bf16 v107, v79, v109
    v_dot2c_f32_bf16 v104, v240, v109
    v_dot2c_f32_bf16 v105, v240, v240
    v_dot2c_f32_bf16 v104, v241, v109
    v_dot2c_f32_bf16 v105, v241, v241
    v_cvt_pk_bf16_f32 v110, v106, v106
    v_dot2c_f32_bf16 v104, v242, v109
    v_dot2c_f32_bf16 v105, v242, v242
    v_cvt_pk_bf16_f32 v111, v107, v107
    v_dot2c_f32_bf16 v104, v243, v109
    v_dot2c_f32_bf16 v105, v243, v243
    v_and_b32 v110, 0xffff0000, v110
    v_dot2c_f32_bf16 v104, v244, v109
    v_dot2c_f32_bf16 v105, v244, v244
    v_and_b32 v111, 0xffff0000, v111
    v_dot2c_f32_bf16 v104, v245, v109
    v_dot2c_f32_bf16 v105, v245, v245
    v_sub_f32 v110, v106, v110
    s_lshl2_add_u32 m0, s73, 77184
    s_nop 0
    buffer_load_dwordx4 v3, s[32:35], s87 offen lds
    v_dot2c_f32_bf16 v104, v246, v109
    v_dot2c_f32_bf16 v105, v246, v246
    v_sub_f32 v111, v107, v111
    v_dot2c_f32_bf16 v104, v247, v109
    v_dot2c_f32_bf16 v105, v247, v247
    v_cvt_pk_bf16_f32 v106, v106, v110
    v_dot2c_f32_bf16 v104, v248, v109
    v_dot2c_f32_bf16 v105, v248, v248
    v_cvt_pk_bf16_f32 v107, v107, v111
    v_dot2c_f32_bf16 v104, v249, v109
    v_dot2c_f32_bf16 v105, v249, v249
    ds_write_b32 v56, v106
    v_dot2c_f32_bf16 v104, v250, v109
    v_dot2c_f32_bf16 v105, v250, v250
    ds_write_b32 v56, v107 offset:1024
    v_dot2c_f32_bf16 v104, v251, v109
    v_dot2c_f32_bf16 v105, v251, v251
    v_dot2c_f32_bf16 v104, v252, v109
    v_dot2c_f32_bf16 v105, v252, v252
    v_dot2c_f32_bf16 v104, v253, v109
    v_dot2c_f32_bf16 v105, v253, v253
    v_dot2c_f32_bf16 v104, v254, v109
    v_dot2c_f32_bf16 v105, v254, v254
    v_dot2c_f32_bf16 v104, v255, v109
    v_dot2c_f32_bf16 v105, v255, v255
    s_lshl2_add_u32 m0, s73, 98816
    s_nop 0
    buffer_load_dwordx4 v3, s[32:35], s88 offen lds
    s_waitcnt lgkmcnt(0)
    s_barrier
    v_mfma_f32_32x32x16_bf16 v[16:31], v[72:75], v[240:243], v[16:31]
    ds_read_b128 v[64:67], v15
    ds_read_b128 v[68:71], v15 offset:1024
    v_mov_b32 v118, v104
    v_mov_b32 v119, v105
    v_mfma_f32_32x32x16_bf16 v[32:47], v[76:79], v[240:243], v[32:47]
    s_lshl2_add_u32 m0, s73, 99840
    s_nop 0
    buffer_load_dwordx4 v3, s[32:35], s89 offen lds
    v_permlane32_swap_b32 v104, v118
    v_permlane32_swap_b32 v105, v119
    v_add_f32 v104, v104, v118
    s_lshl2_add_u32 m0, s73, 100864
    s_nop 0
    buffer_load_dwordx4 v3, s[32:35], s90 offen lds
    v_mfma_f32_32x32x16_bf16 v[16:31], a[40:43], v[244:247], v[16:31]
    v_add_f32 v105, v105, v119
    v_mul_f32 v104, 0.001953125, v104
    v_mul_f32 v105, 0.001953125, v105
    s_lshl2_add_u32 m0, s73, 101888
    s_nop 0
    buffer_load_dwordx4 v3, s[32:35], s91 offen lds
    v_mfma_f32_32x32x16_bf16 v[32:47], a[44:47], v[244:247], v[32:47]
    v_fma_f32 v105, -v104, v104, v105
    v_cvt_pk_bf16_f32 v112, -v104, -v104
    v_max_f32 v105, 0, v105
    s_add_u32 s9, s5, 176128
    s_add_u32 m0, s8, 123520
    s_nop 0
    buffer_load_dwordx4 v123, s[44:47], s9 offen offset:0 lds
    v_cvt_pk_bf16_f32 v105, v105, v105
    v_mfma_f32_32x32x16_bf16 v[16:31], a[48:51], v[248:251], v[16:31]
    v_and_b32 v105, 0xffff0000, v105
    v_add_f32 v105, 0x3727c5ac, v105
    s_add_u32 m0, s8, 123520
    s_nop 0
    buffer_load_dwordx4 v124, s[44:47], s9 offen offset:1024 lds
    v_cvt_pk_bf16_f32 v105, v105, v105
    v_and_b32 v105, 0xffff0000, v105
    v_mfma_f32_32x32x16_bf16 v[32:47], a[52:55], v[248:251], v[32:47]
    v_sqrt_f32 v105, v105
    s_add_u32 m0, s8, 123520
    s_nop 0
    buffer_load_dwordx4 v125, s[44:47], s9 offen offset:2048 lds
    v_cvt_pk_bf16_f32 v105, v105, v105
    v_and_b32 v105, 0xffff0000, v105
    v_mfma_f32_32x32x16_bf16 v[16:31], a[56:59], v[252:255], v[16:31]
    v_rcp_f32 v117, v105
    s_add_u32 m0, s8, 135824
    s_nop 0
    buffer_load_dwordx4 v123, s[48:51], s9 offen offset:0 lds
    v_mov_b32 v113, v112
    v_mov_b32 v114, v112
    v_mov_b32 v115, v112
    v_mfma_f32_32x32x16_bf16 v[32:47], a[60:63], v[252:255], v[32:47]
    s_add_u32 m0, s8, 135824
    s_nop 0
    buffer_load_dwordx4 v124, s[48:51], s9 offen offset:1024 lds
    v_mul_f32 v116, 1.4426950408889634, v117
    v_mov_b32 v4, v88
    v_mov_b32 v5, v89
    s_add_u32 m0, s8, 135824
    s_nop 0
    buffer_load_dwordx4 v125, s[48:51], s9 offen offset:2048 lds
    s_waitcnt lgkmcnt(1)
    v_mfma_f32_32x32x16_bf16 v[16:31], v[64:67], v[112:115], v[16:31]
    s_waitcnt lgkmcnt(0)
    v_mfma_f32_32x32x16_bf16 v[32:47], v[68:71], v[112:115], v[32:47]
    s_add_u32 s97, s68, 0
    s_and_b32 s97, s97, 3
    s_lshl_b32 s98, s97, 12
    s_add_u32 s98, s98, 74112
    v_add_u32 v8, s98, v57
    s_add_u32 s97, s68, 1
    s_and_b32 s97, s97, 3
    s_lshl_b32 s98, s97, 12
    s_add_u32 s98, s98, 74112
    v_add_u32 v9, s98, v57
    s_add_u32 s97, s68, 2
    s_and_b32 s97, s97, 3
    s_lshl_b32 s98, s97, 12
    s_add_u32 s98, s98, 74112
    v_add_u32 v10, s98, v57
    s_add_u32 s97, s68, 3
    s_and_b32 s97, s97, 3
    s_lshl_b32 s98, s97, 12
    s_add_u32 s98, s98, 74112
    v_add_u32 v11, s98, v57
    s_lshl_b32 s76, s70, 4
    s_add_u32 s76, s76, s69
    s_lshl2_add_u32 s76, s76, s68
    s_mul_i32 s76, s76, 640
    s_add_u32 s76, s76, 10485760
    v_cvt_pk_bf16_f32 v16, v16, v17
    v_cvt_pk_bf16_f32 v17, v18, v19
    v_cvt_pk_bf16_f32 v18, v20, v21
    v_cvt_pk_bf16_f32 v19, v22, v23
    v_cvt_pk_bf16_f32 v20, v24, v25
    v_cvt_pk_bf16_f32 v21, v26, v27
    v_cvt_pk_bf16_f32 v22, v28, v29
    v_cvt_pk_bf16_f32 v23, v30, v31
    v_mfma_f32_32x32x16_bf16 v[64:79], v[96:99], v[16:19], 0
    s_nop 0
    v_mfma_f32_32x32x16_bf16 v[80:95], v[100:103], v[20:23], 0
    v_pk_mul_f32 v[32:33], v[32:33], v[116:117] op_sel:[0,1] op_sel_hi:[1,1]
    v_pk_mul_f32 v[34:35], v[34:35], v[116:117] op_sel:[0,1] op_sel_hi:[1,1]
    v_pk_mul_f32 v[36:37], v[36:37], v[116:117] op_sel:[0,1] op_sel_hi:[1,1]
    v_pk_mul_f32 v[38:39], v[38:39], v[116:117] op_sel:[0,1] op_sel_hi:[1,1]
    v_pk_mul_f32 v[40:41], v[40:41], v[116:117] op_sel:[0,1] op_sel_hi:[1,1]
    v_pk_mul_f32 v[42:43], v[42:43], v[116:117] op_sel:[0,1] op_sel_hi:[1,1]
    v_pk_mul_f32 v[44:45], v[44:45], v[116:117] op_sel:[0,1] op_sel_hi:[1,1]
    v_pk_mul_f32 v[46:47], v[46:47], v[116:117] op_sel:[0,1] op_sel_hi:[1,1]
    v_cvt_pk_bf16_f32 v32, v32, v33
    v_cvt_pk_bf16_f32 v33, v34, v35
    v_cvt_pk_bf16_f32 v34, v36, v37
    v_cvt_pk_bf16_f32 v35, v38, v39
    v_cvt_pk_bf16_f32 v36, v40, v41
    v_cvt_pk_bf16_f32 v37, v42, v43
    v_cvt_pk_bf16_f32 v38, v44, v45
    v_cvt_pk_bf16_f32 v39, v46, v47
    v_xor_b32 v110, 16, v49
    ds_write_b128 v49, v[32:35]
HOP_2:
    s_cbranch_execz HR_3
    ds_write_b128 v110, v[36:39]
    v_max3_f32 v118, v64, v65, v66
    v_max3_f32 v119, v67, v68, v69
    v_max3_f32 v118, v118, v70, v71
    v_max3_f32 v119, v119, v72, v73
    v_max3_f32 v118, v118, v74, v75
    v_max3_f32 v119, v119, v76, v77
    v_max3_f32 v118, v118, v78, v79
    v_max_f32 v118, v118, v119
    v_mul_f32 v118, v118, v116
    v_pk_fma_f32 v[64:65], v[64:65], v[116:117], v[118:119] op_sel_hi:[1,0,0] neg_lo:[0,0,1] neg_hi:[0,0,1]
    s_add_u32 m0, s8, 0
    s_nop 0
    buffer_load_dwordx4 v123, s[44:47], s6 offen offset:0 lds
    v_pk_fma_f32 v[66:67], v[66:67], v[116:117], v[118:119] op_sel_hi:[1,0,0] neg_lo:[0,0,1] neg_hi:[0,0,1]
    v_pk_fma_f32 v[68:69], v[68:69], v[116:117], v[118:119] op_sel_hi:[1,0,0] neg_lo:[0,0,1] neg_hi:[0,0,1]
    v_pk_fma_f32 v[70:71], v[70:71], v[116:117], v[118:119] op_sel_hi:[1,0,0] neg_lo:[0,0,1] neg_hi:[0,0,1]
    v_pk_fma_f32 v[72:73], v[72:73], v[116:117], v[118:119] op_sel_hi:[1,0,0] neg_lo:[0,0,1] neg_hi:[0,0,1]
    v_pk_fma_f32 v[74:75], v[74:75], v[116:117], v[118:119] op_sel_hi:[1,0,0] neg_lo:[0,0,1] neg_hi:[0,0,1]
    v_pk_fma_f32 v[76:77], v[76:77], v[116:117], v[118:119] op_sel_hi:[1,0,0] neg_lo:[0,0,1] neg_hi:[0,0,1]
    v_pk_fma_f32 v[78:79], v[78:79], v[116:117], v[118:119] op_sel_hi:[1,0,0] neg_lo:[0,0,1] neg_hi:[0,0,1]
    v_exp_f32 v64, v64
    v_exp_f32 v65, v65
    v_exp_f32 v66, v66
    s_add_u32 m0, s8, 0
    s_nop 0
    buffer_load_dwordx4 v124, s[44:47], s6 offen offset:1024 lds
    v_exp_f32 v67, v67
    v_exp_f32 v68, v68
    v_exp_f32 v69, v69
    v_exp_f32 v70, v70
    v_exp_f32 v71, v71
    v_exp_f32 v72, v72
    v_exp_f32 v73, v73
    v_exp_f32 v74, v74
    v_exp_f32 v75, v75
    s_add_u32 m0, s8, 0
    s_nop 0
    buffer_load_dwordx4 v125, s[44:47], s6 offen offset:2048 lds
    v_exp_f32 v76, v76
    v_exp_f32 v77, v77
    v_exp_f32 v78, v78
    v_exp_f32 v79, v79
    v_pk_add_f32 v[118:119], v[64:65], v[66:67]
    v_pk_add_f32 v[118:119], v[118:119], v[68:69]
    v_pk_add_f32 v[118:119], v[118:119], v[70:71]
    v_pk_add_f32 v[118:119], v[118:119], v[72:73]
    v_pk_add_f32 v[118:119], v[118:119], v[74:75]
    v_pk_add_f32 v[118:119], v[118:119], v[76:77]
    s_add_u32 m0, s8, 12304
    s_nop 0
    buffer_load_dwordx4 v123, s[48:51], s6 offen offset:0 lds
    v_pk_add_f32 v[118:119], v[118:119], v[78:79]
    v_add_f32 v118, v118, v119
    v_rcp_f32 v118, v118
    s_nop 0
    v_pk_mul_f32 v[64:65], v[64:65], v[118:119] op_sel_hi:[1,0]
    v_pk_mul_f32 v[66:67], v[66:67], v[118:119] op_sel_hi:[1,0]
    v_pk_mul_f32 v[68:69], v[68:69], v[118:119] op_sel_hi:[1,0]
    v_pk_mul_f32 v[70:71], v[70:71], v[118:119] op_sel_hi:[1,0]
    v_pk_mul_f32 v[72:73], v[72:73], v[118:119] op_sel_hi:[1,0]
    v_pk_mul_f32 v[74:75], v[74:75], v[118:119] op_sel_hi:[1,0]
    v_pk_mul_f32 v[76:77], v[76:77], v[118:119] op_sel_hi:[1,0]
    s_add_u32 m0, s8, 12304
    s_nop 0
    buffer_load_dwordx4 v124, s[48:51], s6 offen offset:1024 lds
    v_pk_mul_f32 v[78:79], v[78:79], v[118:119] op_sel_hi:[1,0]
    v_cvt_pk_bf16_f32 v16, v64, v65
    v_cvt_pk_bf16_f32 v17, v66, v67
    v_cvt_pk_bf16_f32 v18, v68, v69
    v_cvt_pk_bf16_f32 v19, v70, v71
    v_cvt_pk_bf16_f32 v20, v72, v73
    v_cvt_pk_bf16_f32 v21, v74, v75
    v_cvt_pk_bf16_f32 v22, v76, v77
    v_cvt_pk_bf16_f32 v23, v78, v79
    s_add_u32 m0, s8, 12304
    s_nop 0
    buffer_load_dwordx4 v125, s[48:51], s6 offen offset:2048 lds
    v_xor_b32 v111, 16, v48
    ds_write_b128 v48, v[16:19]
    ds_write_b128 v111, v[20:23]
    v_max3_f32 v118, v80, v81, v82
    v_max3_f32 v119, v83, v84, v85
    v_max3_f32 v118, v118, v86, v87
    v_max3_f32 v119, v119, v88, v89
    v_max3_f32 v118, v118, v90, v91
    v_max3_f32 v119, v119, v92, v93
    v_max3_f32 v118, v118, v94, v95
    v_max_f32 v118, v118, v119
    v_mul_f32 v118, v118, v116
    v_pk_fma_f32 v[80:81], v[80:81], v[116:117], v[118:119] op_sel_hi:[1,0,0] neg_lo:[0,0,1] neg_hi:[0,0,1]
    v_pk_fma_f32 v[82:83], v[82:83], v[116:117], v[118:119] op_sel_hi:[1,0,0] neg_lo:[0,0,1] neg_hi:[0,0,1]
    v_pk_fma_f32 v[84:85], v[84:85], v[116:117], v[118:119] op_sel_hi:[1,0,0] neg_lo:[0,0,1] neg_hi:[0,0,1]
    v_pk_fma_f32 v[86:87], v[86:87], v[116:117], v[118:119] op_sel_hi:[1,0,0] neg_lo:[0,0,1] neg_hi:[0,0,1]
    v_pk_fma_f32 v[88:89], v[88:89], v[116:117], v[118:119] op_sel_hi:[1,0,0] neg_lo:[0,0,1] neg_hi:[0,0,1]
    v_pk_fma_f32 v[90:91], v[90:91], v[116:117], v[118:119] op_sel_hi:[1,0,0] neg_lo:[0,0,1] neg_hi:[0,0,1]
    v_pk_fma_f32 v[92:93], v[92:93], v[116:117], v[118:119] op_sel_hi:[1,0,0] neg_lo:[0,0,1] neg_hi:[0,0,1]
    v_pk_fma_f32 v[94:95], v[94:95], v[116:117], v[118:119] op_sel_hi:[1,0,0] neg_lo:[0,0,1] neg_hi:[0,0,1]
    v_exp_f32 v80, v80
    v_exp_f32 v81, v81
    v_exp_f32 v82, v82
    s_add_u32 s9, s6, 176128
    s_add_u32 m0, s8, 24704
    s_nop 0
    buffer_load_dwordx4 v123, s[44:47], s9 offen offset:0 lds
    v_exp_f32 v83, v83
    v_exp_f32 v84, v84
    v_exp_f32 v85, v85
    v_exp_f32 v86, v86
    v_exp_f32 v87, v87
    v_exp_f32 v88, v88
    v_exp_f32 v89, v89
    v_exp_f32 v90, v90
    v_exp_f32 v91, v91
    v_exp_f32 v92, v92
    v_exp_f32 v93, v93
    v_exp_f32 v94, v94
    v_exp_f32 v95, v95
    v_pk_add_f32 v[118:119], v[80:81], v[82:83]
    v_pk_add_f32 v[118:119], v[118:119], v[84:85]
    v_pk_add_f32 v[118:119], v[118:119], v[86:87]
    v_pk_add_f32 v[118:119], v[118:119], v[88:89]
    v_pk_add_f32 v[118:119], v[118:119], v[90:91]
    v_pk_add_f32 v[118:119], v[118:119], v[92:93]
    s_add_u32 m0, s8, 24704
    s_nop 0
    buffer_load_dwordx4 v124, s[44:47], s9 offen offset:1024 lds
    v_pk_add_f32 v[118:119], v[118:119], v[94:95]
    v_add_f32 v118, v118, v119
    v_rcp_f32 v118, v118
    s_nop 0
    v_pk_mul_f32 v[80:81], v[80:81], v[118:119] op_sel_hi:[1,0]
    v_pk_mul_f32 v[82:83], v[82:83], v[118:119] op_sel_hi:[1,0]
    v_pk_mul_f32 v[84:85], v[84:85], v[118:119] op_sel_hi:[1,0]
    v_pk_mul_f32 v[86:87], v[86:87], v[118:119] op_sel_hi:[1,0]
    v_pk_mul_f32 v[88:89], v[88:89], v[118:119] op_sel_hi:[1,0]
    v_pk_mul_f32 v[90:91], v[90:91], v[118:119] op_sel_hi:[1,0]
    v_pk_mul_f32 v[92:93], v[92:93], v[118:119] op_sel_hi:[1,0]
    v_pk_mul_f32 v[94:95], v[94:95], v[118:119] op_sel_hi:[1,0]
    v_cvt_pk_bf16_f32 v24, v80, v81
    v_cvt_pk_bf16_f32 v25, v82, v83
    v_cvt_pk_bf16_f32 v26, v84, v85
    v_cvt_pk_bf16_f32 v27, v86, v87
    v_cvt_pk_bf16_f32 v28, v88, v89
    v_cvt_pk_bf16_f32 v29, v90, v91
    v_cvt_pk_bf16_f32 v30, v92, v93
    v_cvt_pk_bf16_f32 v31, v94, v95
    s_add_u32 m0, s8, 24704
    s_nop 0
    buffer_load_dwordx4 v125, s[44:47], s9 offen offset:2048 lds
    v_xor_b32 v48, 64, v48
    v_xor_b32 v111, 16, v48
    ds_write_b128 v48, v[24:27]
    ds_write_b128 v111, v[28:31]
    s_waitcnt vmcnt(27)
    v_readfirstlane_b32 s75, v121
    s_mov_b32 s92, 0
GN_5:
    s_cmp_lg_u32 s75, 0
    s_cbranch_scc1 GN_4
    s_add_u32 s92, s92, 1
    s_cmp_gt_u32 s92, 400000
    s_cbranch_scc1 GN_4
    s_mov_b64 exec, 1
    buffer_load_dwordx2 v[120:121], v12, s[60:63], 0 offen sc1
    s_mov_b64 exec, -1
    s_waitcnt vmcnt(0)
    v_readfirstlane_b32 s75, v121
    s_branch GN_5
GN_4:
    v_readfirstlane_b32 s74, v120
    s_getreg_b32 s92, hwreg(HW_REG_XCC_ID, 0, 4)
    s_add_u32 s92, s92, 1
    s_lshl_b32 s92, s92, 25
    s_xor_b32 s19, s75, s92
    s_mov_b32 s18, s74
    s_mov_b32 s17, 0
    s_waitcnt vmcnt(15)
    s_waitcnt lgkmcnt(0)
    s_barrier
    ds_read_b64_tr_b16 v[64:65], v50 offset:0
    ds_read_b64_tr_b16 v[66:67], v51 offset:0
    ds_read_b64_tr_b16 v[68:69], v52 offset:0
    ds_read_b64_tr_b16 v[70:71], v53 offset:0
    ds_read_b64_tr_b16 v[72:73], v50 offset:4096
    ds_read_b64_tr_b16 v[74:75], v51 offset:4096
    ds_read_b64_tr_b16 v[76:77], v52 offset:2048
    ds_read_b64_tr_b16 v[78:79], v53 offset:2048
    ds_read_b64_tr_b16 v[80:81], v50 offset:8192
    ds_read_b64_tr_b16 v[82:83], v51 offset:8192
    ds_read_b64_tr_b16 v[84:85], v52 offset:4096
    ds_read_b64_tr_b16 v[86:87], v53 offset:4096
    ds_read_b64_tr_b16 v[88:89], v50 offset:12288
    ds_read_b64_tr_b16 v[90:91], v51 offset:12288
    ds_read_b64_tr_b16 v[92:93], v52 offset:6144
    ds_read_b64_tr_b16 v[94:95], v53 offset:6144
    s_cmp_lg_u32 s68, 0
    s_cbranch_scc1 PB_6
    v_mov_b32 v120, s74
    v_mov_b32 v121, s75
    s_mov_b64 exec, 1
    buffer_store_dwordx2 v[120:121], v12, s[64:67], s11 offen sc1
    s_mov_b64 exec, -1
PB_6:
    ds_read_b64_tr_b16 v[16:17], v8 offset:0
    ds_read_b64_tr_b16 v[18:19], v8 offset:256
    ds_read_b64_tr_b16 v[20:21], v8 offset:1024
    ds_read_b64_tr_b16 v[22:23], v8 offset:1280
    ds_read_b64_tr_b16 v[24:25], v8 offset:2048
    ds_read_b64_tr_b16 v[26:27], v8 offset:2304
    ds_read_b64_tr_b16 v[28:29], v8 offset:3072
    ds_read_b64_tr_b16 v[30:31], v8 offset:3328
    s_waitcnt lgkmcnt(15)
    v_mfma_f32_16x16x32_bf16 v[32:35], v[64:67], v[68:71], 0
    v_mfma_f32_16x16x32_bf16 v[36:39], v[64:67], v[60:63], 0
    v_mfma_f32_16x16x32_bf16 v[32:35], v[72:75], v[76:79], v[32:35]
    v_mfma_f32_16x16x32_bf16 v[36:39], v[72:75], v[60:63], v[36:39]
    s_waitcnt lgkmcnt(12)
    v_mfma_f32_16x16x32_bf16 v[32:35], v[80:83], v[84:87], v[32:35]
    v_mfma_f32_16x16x32_bf16 v[36:39], v[80:83], v[60:63], v[36:39]
    s_waitcnt lgkmcnt(8)
    v_mfma_f32_16x16x32_bf16 v[32:35], v[88:91], v[92:95], v[32:35]
    v_mfma_f32_16x16x32_bf16 v[36:39], v[88:91], v[60:63], v[36:39]
    ds_read_b64_tr_b16 v[64:65], v8 offset:24704
    ds_read_b64_tr_b16 v[66:67], v8 offset:24960
    ds_read_b64_tr_b16 v[68:69], v8 offset:25728
    ds_read_b64_tr_b16 v[70:71], v8 offset:25984
    ds_read_b64_tr_b16 v[72:73], v8 offset:26752
    ds_read_b64_tr_b16 v[74:75], v8 offset:27008
    ds_read_b64_tr_b16 v[76:77], v8 offset:27776
    ds_read_b64_tr_b16 v[78:79], v8 offset:28032
    v_cvt_pk_bf16_f32 v32, v32, v33
    v_cvt_pk_bf16_f32 v33, v34, v35
    buffer_store_dwordx2 v[32:33], v54, s[64:67], s76 offen sc1
    v_cvt_pk_bf16_f32 v36, v36, v37
    v_cvt_pk_bf16_f32 v37, v38, v39
    buffer_store_dwordx2 v[36:37], v55, s[64:67], s76 offen sc1
    ds_read_b64_tr_b16 v[80:81], v8 offset:0
    ds_read_b64_tr_b16 v[82:83], v8 offset:256
    ds_read_b64_tr_b16 v[84:85], v9 offset:0
    ds_read_b64_tr_b16 v[86:87], v9 offset:256
    ds_read_b64_tr_b16 v[88:89], v10 offset:0
    ds_read_b64_tr_b16 v[90:91], v10 offset:256
    ds_read_b64_tr_b16 v[92:93], v11 offset:0
    ds_read_b64_tr_b16 v[94:95], v11 offset:256
    v_mov_b32 v110, 0
    v_mov_b32 v111, 0
    s_waitcnt lgkmcnt(15)
    v_dot2c_f32_bf16 v111, v16, v109
    v_dot2c_f32_bf16 v110, v64, v109
    v_dot2c_f32_bf16 v111, v17, v109
    v_dot2c_f32_bf16 v110, v65, v109
    v_dot2c_f32_bf16 v111, v18, v109
    s_waitcnt lgkmcnt(14)
    v_dot2c_f32_bf16 v110, v66, v109
    v_dot2c_f32_bf16 v111, v19, v109
    v_dot2c_f32_bf16 v110, v67, v109
    v_dot2c_f32_bf16 v111, v20, v109
    s_waitcnt lgkmcnt(13)
    v_dot2c_f32_bf16 v110, v68, v109
    v_dot2c_f32_bf16 v111, v21, v109
    v_dot2c_f32_bf16 v110, v69, v109
    v_dot2c_f32_bf16 v111, v22, v109
    s_waitcnt lgkmcnt(12)
    v_dot2c_f32_bf16 v110, v70, v109
    v_dot2c_f32_bf16 v111, v23, v109
    v_dot2c_f32_bf16 v110, v71, v109
    v_dot2c_f32_bf16 v111, v24, v109
    s_waitcnt lgkmcnt(11)
    v_dot2c_f32_bf16 v110, v72, v109
    v_dot2c_f32_bf16 v111, v25, v109
    v_dot2c_f32_bf16 v110, v73, v109
    v_dot2c_f32_bf16 v111, v26, v109
    s_waitcnt lgkmcnt(10)
    v_dot2c_f32_bf16 v110, v74, v109
    v_dot2c_f32_bf16 v111, v27, v109
    v_dot2c_f32_bf16 v110, v75, v109
    v_dot2c_f32_bf16 v111, v28, v109
    s_waitcnt lgkmcnt(9)
    v_dot2c_f32_bf16 v110, v76, v109
    v_dot2c_f32_bf16 v111, v29, v109
    v_dot2c_f32_bf16 v110, v77, v109
    v_dot2c_f32_bf16 v111, v30, v109
    s_waitcnt lgkmcnt(8)
    v_dot2c_f32_bf16 v110, v78, v109
    v_dot2c_f32_bf16 v111, v31, v109
    v_dot2c_f32_bf16 v110, v79, v109
    s_nop 2
    v_add_f32 v111, v111, v110
    v_cvt_pk_bf16_f32 v110, v111, v111
    v_and_b32 v110, 0xffff0000, v110
    v_sub_f32 v110, v111, v110
    v_cvt_pk_bf16_f32 v111, v111, v110
    ds_write_b32 v56, v111 offset:2048
    s_waitcnt lgkmcnt(7)
    v_mfma_f32_32x32x16_bf16 v[48:63], v[80:83], v[128:131], 0
    ds_read_b64_tr_b16 v[64:65], v8 offset:1024
    ds_read_b64_tr_b16 v[66:67], v8 offset:1280
    v_and_b32 v110, 31, v0
    v_lshlrev_b32 v110, 10, v110
    v_lshrrev_b32 v111, 5, v0
    v_lshl_add_u32 v110, v111, 4, v110
    s_waitcnt lgkmcnt(7)
    v_mfma_f32_32x32x16_bf16 v[48:63], v[84:87], v[132:135], v[48:63]
    ds_read_b64_tr_b16 v[68:69], v9 offset:1024
    ds_read_b64_tr_b16 v[70:71], v9 offset:1280
    s_and_b32 s96, s70, 7
    s_and_b32 s97, s68, 1
    s_lshl1_add_u32 s96, s96, s97
    s_lshl_b32 s96, s96, 6
    s_and_b32 s77, s68, 2
    s_add_u32 s77, s77, s27
    s_lshl_b32 s77, s77, 15
    s_add_u32 s77, s77, s96
    buffer_load_dwordx4 v[40:43], v110, s[28:31], s77 offen
    s_waitcnt lgkmcnt(7)
    v_mfma_f32_32x32x16_bf16 v[48:63], v[88:91], v[136:139], v[48:63]
    ds_read_b64_tr_b16 v[72:73], v10 offset:1024
    ds_read_b64_tr_b16 v[74:75], v10 offset:1280
    buffer_load_dwordx4 v[44:47], v110, s[28:31], s77 offen offset:32
    s_waitcnt vmcnt(2) lgkmcnt(6)
    s_barrier
    s_cmp_lg_u32 s68, 0
    s_cbranch_scc1 PB_7
    s_lshl_b32 s92, s70, 7
    s_lshl_b32 s93, s69, 3
    s_add_u32 s92, s92, s93
    s_add_u32 s92, s92, 12582912
    v_mov_b32 v118, s74
    v_mov_b32 v119, s75
    s_mov_b64 exec, 1
    buffer_store_dwordx2 v[118:119], v12, s[64:67], s92 offen sc1
    s_mov_b64 exec, -1
PB_7:
    v_mfma_f32_32x32x16_bf16 v[48:63], v[92:95], v[140:143], v[48:63]
    ds_read_b64_tr_b16 v[76:77], v11 offset:1024
    ds_read_b64_tr_b16 v[78:79], v11 offset:1280
    s_add_u32 m0, s8, 37008
    s_nop 0
    buffer_load_dwordx4 v123, s[48:51], s9 offen offset:0 lds
    s_add_u32 m0, s8, 37008
    s_nop 0
    buffer_load_dwordx4 v124, s[48:51], s9 offen offset:1024 lds
    s_add_u32 m0, s8, 37008
    s_nop 0
    buffer_load_dwordx4 v125, s[48:51], s9 offen offset:2048 lds
    s_waitcnt lgkmcnt(6)
    v_mfma_f32_32x32x16_bf16 v[48:63], v[64:67], v[144:147], v[48:63]
    ds_read_b64_tr_b16 v[80:81], v8 offset:2048
    ds_read_b64_tr_b16 v[82:83], v8 offset:2304
    v_add_u32 v127, 123520, v127
    v_add_u32 v108, 123520, v108
    ds_read_b64_tr_b16 a[72:73], v108 offset:0
    ds_read_b64_tr_b16 a[74:75], v108 offset:48
    ds_read_b64_tr_b16 a[76:77], v108 offset:12304
    s_waitcnt lgkmcnt(9)
    v_mfma_f32_32x32x16_bf16 v[48:63], v[68:71], v[148:151], v[48:63]
    ds_read_b64_tr_b16 v[84:85], v9 offset:2048
    ds_read_b64_tr_b16 v[86:87], v9 offset:2304
    ds_read_b64_tr_b16 a[78:79], v108 offset:12352
    ds_read_b64_tr_b16 a[80:81], v127 offset:32
    ds_read_b64_tr_b16 a[82:83], v127 offset:80
    s_waitcnt lgkmcnt(12)
    v_mfma_f32_32x32x16_bf16 v[48:63], v[72:75], v[152:155], v[48:63]
    ds_read_b64_tr_b16 v[88:89], v10 offset:2048
    ds_read_b64_tr_b16 v[90:91], v10 offset:2304
    ds_read_b64_tr_b16 a[84:85], v108 offset:1536
    ds_read_b64_tr_b16 a[86:87], v108 offset:1584
    ds_read_b64_tr_b16 a[88:89], v108 offset:13840
    s_waitcnt lgkmcnt(15)
    v_mfma_f32_32x32x16_bf16 v[48:63], v[76:79], v[156:159], v[48:63]
    ds_read_b64_tr_b16 v[92:93], v11 offset:2048
    ds_read_b64_tr_b16 v[94:95], v11 offset:2304
    ds_read_b64_tr_b16 a[90:91], v108 offset:13888
    ds_read_b64_tr_b16 a[92:93], v127 offset:1568
    ds_read_b64_tr_b16 a[94:95], v127 offset:1616
    s_waitcnt lgkmcnt(15)
    v_mfma_f32_32x32x16_bf16 v[48:63], v[80:83], v[160:163], v[48:63]
    ds_read_b64_tr_b16 v[64:65], v8 offset:3072
    ds_read_b64_tr_b16 v[66:67], v8 offset:3328
    v_add_u32 v127, -123520, v127
    v_add_u32 v108, -123520, v108
    ds_read_b64_tr_b16 a[96:97], v108 offset:0
    ds_read_b64_tr_b16 a[98:99], v108 offset:48
    ds_read_b64_tr_b16 a[100:101], v108 offset:12304
    s_waitcnt lgkmcnt(15)
    v_mfma_f32_32x32x16_bf16 v[48:63], v[84:87], v[164:167], v[48:63]
    ds_read_b64_tr_b16 v[68:69], v9 offset:3072
    ds_read_b64_tr_b16 v[70:71], v9 offset:3328
    ds_read_b64_tr_b16 a[102:103], v108 offset:12352
    ds_read_b64_tr_b16 a[104:105], v127 offset:32
    ds_read_b64_tr_b16 a[106:107], v127 offset:80
    s_waitcnt lgkmcnt(15)
    v_mfma_f32_32x32x16_bf16 v[48:63], v[88:91], v[168:171], v[48:63]
    ds_read_b64_tr_b16 v[72:73], v10 offset:3072
    ds_read_b64_tr_b16 v[74:75], v10 offset:3328
    ds_read_b64_tr_b16 a[108:109], v108 offset:1536
    ds_read_b64_tr_b16 a[110:111], v108 offset:1584
    ds_read_b64_tr_b16 a[112:113], v108 offset:13840
    s_waitcnt lgkmcnt(15)
    v_mfma_f32_32x32x16_bf16 v[48:63], v[92:95], v[172:175], v[48:63]
    ds_read_b64_tr_b16 v[76:77], v11 offset:3072
    ds_read_b64_tr_b16 v[78:79], v11 offset:3328
    ds_read_b64_tr_b16 a[114:115], v108 offset:13888
    ds_read_b64_tr_b16 a[116:117], v127 offset:1568
    ds_read_b64_tr_b16 a[118:119], v127 offset:1616
    s_waitcnt lgkmcnt(15)
    v_mfma_f32_32x32x16_bf16 v[48:63], v[64:67], v[176:179], v[48:63]
    ds_read_b64_tr_b16 v[80:81], v8 offset:24704
    ds_read_b64_tr_b16 v[82:83], v8 offset:24960
    s_add_u32 m0, s8, 123520
    s_nop 0
    buffer_load_dwordx4 v123, s[44:47], s7 offen offset:0 lds
    v_lshrrev_b32 v110, 5, v0
    v_and_b32 v111, 31, v0
    v_lshlrev_b32 v111, 4, v111
    s_waitcnt lgkmcnt(15)
    v_mfma_f32_32x32x16_bf16 v[48:63], v[68:71], v[180:183], v[48:63]
    ds_read_b64_tr_b16 v[84:85], v9 offset:24704
    ds_read_b64_tr_b16 v[86:87], v9 offset:24960
    s_add_u32 m0, s8, 123520
    s_nop 0
    buffer_load_dwordx4 v124, s[44:47], s7 offen offset:1024 lds
    v_mul_u32_u24 v1, 1280, v110
    v_add_u32 v1, v1, v111
    s_waitcnt lgkmcnt(12)
    v_mfma_f32_32x32x16_bf16 v[48:63], v[72:75], v[184:187], v[48:63]
    ds_read_b64_tr_b16 v[88:89], v10 offset:24704
    ds_read_b64_tr_b16 v[90:91], v10 offset:24960
    s_add_u32 m0, s8, 123520
    s_nop 0
    buffer_load_dwordx4 v125, s[44:47], s7 offen offset:2048 lds
    v_mul_u32_u24 v3, 544, v110
    v_mov_b32 v5, v3
    v_add_u32 v3, v3, v111
    s_waitcnt lgkmcnt(9)
    v_mfma_f32_32x32x16_bf16 v[48:63], v[76:79], v[188:191], v[48:63]
    ds_read_b64_tr_b16 v[92:93], v11 offset:24704
    ds_read_b64_tr_b16 v[94:95], v11 offset:24960
    s_mul_i32 s96, s68, 1088
    s_add_u32 s96, s96, 115200
    v_add_u32 v3, s96, v3
    s_waitcnt lgkmcnt(6)
    v_mfma_f32_32x32x16_bf16 v[48:63], v[80:83], v[192:195], v[48:63]
    ds_read_b64_tr_b16 v[64:65], v8 offset:25728
    ds_read_b64_tr_b16 v[66:67], v8 offset:25984
    s_min_u32 s71, s68, 2
    s_lshr_b32 s72, s70, 3
    s_lshl4_add_u32 s72, s72, s69
    s_mul_i32 s72, s72, 3
    s_add_u32 s71, s71, s72
    s_lshl_b32 s71, s71, 14
    s_and_b32 s72, s70, 7
    s_lshl_b32 s72, s72, 11
    s_add_u32 s71, s71, s72
    v_lshl_add_u32 v126, v0, 7, s71
    s_mov_b64 exec, 0xffff0000
    v_add_u32 v126, 784384, v126
    s_lshr_b32 s72, s2, 5
    s_cmp_eq_u32 s72, 7
    s_cselect_b64 exec, 0, 0xffff
    s_cmp_eq_u32 s72, 3
    s_cselect_b32 exec_lo, -1, exec_lo
    buffer_load_dword v126, v126, s[52:55], 0 offen
    s_mov_b64 exec, -1
    v_bfe_u32 v110, v0, 3, 1
    v_and_b32 v111, 7, v0
    s_waitcnt lgkmcnt(6)
    v_mfma_f32_32x32x16_bf16 v[48:63], v[84:87], v[196:199], v[48:63]
    ds_read_b64_tr_b16 v[68:69], v9 offset:25728
    ds_read_b64_tr_b16 v[70:71], v9 offset:25984
    s_add_u32 m0, s8, 135824
    s_nop 0
    buffer_load_dwordx4 v123, s[48:51], s7 offen offset:0 lds
    v_lshlrev_b32 v111, 2, v111
    v_lshrrev_b32 v2, 3, v0
    v_mul_u32_u24 v2, 1280, v2
    s_waitcnt lgkmcnt(6)
    v_mfma_f32_32x32x16_bf16 v[48:63], v[88:91], v[200:203], v[48:63]
    ds_read_b64_tr_b16 v[72:73], v10 offset:25728
    ds_read_b64_tr_b16 v[74:75], v10 offset:25984
    v_add_u32 v2, v2, v111
    v_mul_u32_u24 v4, 544, v110
    s_waitcnt lgkmcnt(6)
    v_mfma_f32_32x32x16_bf16 v[48:63], v[92:95], v[204:207], v[48:63]
    ds_read_b64_tr_b16 v[76:77], v11 offset:25728
    ds_read_b64_tr_b16 v[78:79], v11 offset:25984
    s_add_u32 m0, s8, 135824
    s_nop 0
    buffer_load_dwordx4 v124, s[48:51], s7 offen offset:1024 lds
    v_add3_u32 v4, v4, v111, s96
    v_bfe_u32 v110, v0, 4, 1
    s_waitcnt lgkmcnt(6)
    v_mfma_f32_32x32x16_bf16 v[48:63], v[64:67], v[208:211], v[48:63]
    ds_read_b64_tr_b16 v[80:81], v8 offset:26752
    ds_read_b64_tr_b16 v[82:83], v8 offset:27008
    s_add_u32 m0, s8, 135824
    s_nop 0
    buffer_load_dwordx4 v125, s[48:51], s7 offen offset:2048 lds
    v_lshl_add_u32 v4, v110, 1, v4
    v_and_b32 v110, 3, v0
    v_bfe_u32 v111, v0, 2, 1
    s_waitcnt lgkmcnt(6)
    v_mfma_f32_32x32x16_bf16 v[48:63], v[68:71], v[212:215], v[48:63]
    ds_read_b64_tr_b16 v[84:85], v9 offset:26752
    ds_read_b64_tr_b16 v[86:87], v9 offset:27008
    v_lshl_add_u32 v110, v111, 3, v110
    v_bfe_u32 v111, v0, 4, 1
    s_waitcnt lgkmcnt(6)
    v_mfma_f32_32x32x16_bf16 v[48:63], v[72:75], v[216:219], v[48:63]
    ds_read_b64_tr_b16 v[88:89], v10 offset:26752
    ds_read_b64_tr_b16 v[90:91], v10 offset:27008
    v_lshl_add_u32 v110, v111, 2, v110
    v_and_b32 v111, 8, v0
    v_cmp_eq_u32 vcc, 0, v111
    s_waitcnt lgkmcnt(6)
    v_mfma_f32_32x32x16_bf16 v[48:63], v[76:79], v[220:223], v[48:63]
    ds_read_b64_tr_b16 v[92:93], v11 offset:26752
    ds_read_b64_tr_b16 v[94:95], v11 offset:27008
    v_add_u32 v5, 115200, v5
    v_cndmask_b32 v110, 16, v110, vcc
    s_waitcnt lgkmcnt(6)
    v_mfma_f32_32x32x16_bf16 v[48:63], v[80:83], v[224:227], v[48:63]
    ds_read_b64_tr_b16 v[64:65], v8 offset:27776
    ds_read_b64_tr_b16 v[66:67], v8 offset:28032
    v_lshl_add_u32 v5, v110, 5, v5
    v_mov_b32 v6, 0x3f80
    s_waitcnt lgkmcnt(6)
    v_mfma_f32_32x32x16_bf16 v[48:63], v[84:87], v[228:231], v[48:63]
    ds_read_b64_tr_b16 v[68:69], v9 offset:27776
    ds_read_b64_tr_b16 v[70:71], v9 offset:28032
    v_mov_b32 v7, 0x3f800000
    s_lshr_b32 s96, s68, 1
    s_lshl1_add_u32 s96, s70, s96
    s_mul_i32 s76, s96, 20480
    s_and_b32 s96, s68, 1
    s_mul_i32 s96, s96, 640
    s_add_u32 s76, s76, s96
    s_add_u32 s76, s76, 10485760
    s_lshl2_add_u32 s78, s69, s68
    s_lshl_b32 s78, s78, 15
    s_lshl_b32 s96, s70, 11
    s_add_u32 s78, s78, s96
    s_xor_b32 s78, s78, 16384
    s_waitcnt lgkmcnt(6)
    v_mfma_f32_32x32x16_bf16 v[48:63], v[88:91], v[232:235], v[48:63]
    ds_read_b64_tr_b16 v[72:73], v10 offset:27776
    ds_read_b64_tr_b16 v[74:75], v10 offset:28032
    s_and_b32 s96, s11, 0x3f00
    s_lshl_b32 s97, s70, 7
    s_sub_u32 s96, s96, s97
    s_sub_u32 s96, s96, 256
    v_lshl_add_u32 v110, v0, 3, s96
    s_waitcnt lgkmcnt(6)
    v_mfma_f32_32x32x16_bf16 v[48:63], v[92:95], v[236:239], v[48:63]
    ds_read_b64_tr_b16 v[76:77], v11 offset:27776
    ds_read_b64_tr_b16 v[78:79], v11 offset:28032
    v_cmp_gt_u32 vcc, 32, v0
    s_nop 1
    v_cndmask_b32 v122, v110, v122, vcc
    s_waitcnt lgkmcnt(6)
    v_mfma_f32_32x32x16_bf16 v[48:63], v[64:67], v[240:243], v[48:63]
    v_mov_b32 v176, 0
    v_mov_b32 v177, 0
    v_mov_b32 v178, 0
    s_waitcnt lgkmcnt(4)
    v_mfma_f32_32x32x16_bf16 v[48:63], v[68:71], v[244:247], v[48:63]
    ds_read_b128 v[16:19], v15 offset:2048
    v_mov_b32 v179, 0
    v_mov_b32 v180, 0
    s_waitcnt lgkmcnt(3)
    v_mfma_f32_32x32x16_bf16 v[48:63], v[72:75], v[248:251], v[48:63]
    v_mov_b32 v181, 0
    v_mov_b32 v182, 0
    v_mov_b32 v183, 0
    s_lshl_b32 s92, s70, 7
    s_add_u32 s92, s92, 12582912
    buffer_load_dwordx2 v[120:121], v122, s[64:67], s92 offen sc1
    s_waitcnt lgkmcnt(1)
    v_mfma_f32_32x32x16_bf16 v[48:63], v[76:79], v[252:255], v[48:63]
    v_mov_b32 v184, 0
    v_mov_b32 v185, 0
    s_waitcnt lgkmcnt(0)
    v_mfma_f32_32x32x16_bf16 v[48:63], v[16:19], v[112:115], v[48:63]
    s_waitcnt vmcnt(12)
    v_permlane32_swap_b32 v40, v42
    v_permlane32_swap_b32 v41, v43
    s_waitcnt vmcnt(11)
    v_permlane32_swap_b32 v44, v46
    v_permlane32_swap_b32 v45, v47
    s_nop 5
    v_cvt_pk_bf16_f32 v48, v48, v49
    v_cvt_pk_bf16_f32 v49, v50, v51
    v_cvt_pk_bf16_f32 v50, v52, v53
    v_cvt_pk_bf16_f32 v51, v54, v55
    v_cvt_pk_bf16_f32 v52, v56, v57
    v_cvt_pk_bf16_f32 v53, v58, v59
    v_cvt_pk_bf16_f32 v54, v60, v61
    v_cvt_pk_bf16_f32 v55, v62, v63
    v_mfma_f32_32x32x16_bf16 v[64:79], v[96:99], v[48:51], 0
    s_nop 0
    v_mfma_f32_32x32x16_bf16 v[80:95], v[100:103], v[52:55], 0
    v_lshlrev_b32 v224, 16, v40
    v_and_b32 v225, 0xffff0000, v40
    v_lshlrev_b32 v226, 16, v41
    v_and_b32 v227, 0xffff0000, v41
    v_lshlrev_b32 v228, 16, v42
    v_and_b32 v229, 0xffff0000, v42
    v_lshlrev_b32 v230, 16, v43
    v_and_b32 v231, 0xffff0000, v43
    v_lshlrev_b32 v232, 16, v44
    v_and_b32 v233, 0xffff0000, v44
    v_lshlrev_b32 v234, 16, v45
    v_and_b32 v235, 0xffff0000, v45
    v_lshlrev_b32 v236, 16, v46
    v_and_b32 v237, 0xffff0000, v46
    v_lshlrev_b32 v238, 16, v47
    v_and_b32 v239, 0xffff0000, v47
    v_max3_f32 v118, v64, v65, v66
    v_max3_f32 v119, v67, v68, v69
    v_max3_f32 v118, v118, v70, v71
    v_max3_f32 v119, v119, v72, v73
    v_max3_f32 v118, v118, v74, v75
    v_max3_f32 v119, v119, v76, v77
    v_max3_f32 v118, v118, v78, v79
    v_max_f32 v118, v118, v119
    v_mul_f32 v118, v118, v116
    v_pk_fma_f32 v[64:65], v[64:65], v[116:117], v[118:119] op_sel_hi:[1,0,0] neg_lo:[0,0,1] neg_hi:[0,0,1]
    s_waitcnt vmcnt(8)
    ds_read_b64_tr_b16 a[120:121], v108 offset:24704
    v_pk_fma_f32 v[66:67], v[66:67], v[116:117], v[118:119] op_sel_hi:[1,0,0] neg_lo:[0,0,1] neg_hi:[0,0,1]
    v_pk_fma_f32 v[68:69], v[68:69], v[116:117], v[118:119] op_sel_hi:[1,0,0] neg_lo:[0,0,1] neg_hi:[0,0,1]
    v_pk_fma_f32 v[70:71], v[70:71], v[116:117], v[118:119] op_sel_hi:[1,0,0] neg_lo:[0,0,1] neg_hi:[0,0,1]
    v_pk_fma_f32 v[72:73], v[72:73], v[116:117], v[118:119] op_sel_hi:[1,0,0] neg_lo:[0,0,1] neg_hi:[0,0,1]
    v_pk_fma_f32 v[74:75], v[74:75], v[116:117], v[118:119] op_sel_hi:[1,0,0] neg_lo:[0,0,1] neg_hi:[0,0,1]
    v_pk_fma_f32 v[76:77], v[76:77], v[116:117], v[118:119] op_sel_hi:[1,0,0] neg_lo:[0,0,1] neg_hi:[0,0,1]
    v_pk_fma_f32 v[78:79], v[78:79], v[116:117], v[118:119] op_sel_hi:[1,0,0] neg_lo:[0,0,1] neg_hi:[0,0,1]
    v_exp_f32 v64, v64
    v_exp_f32 v65, v65
    v_exp_f32 v66, v66
    s_waitcnt vmcnt(0)
    v_cmp_ne_u64 vcc, s[74:75], v[120:121]
    s_nop 4
    s_cbranch_vccz WF_8
    s_lshl_b32 s92, s70, 7
    s_add_u32 s92, s92, 12582912
    s_mov_b32 s93, 0
    s_mov_b64 s[20:21], -1
WP_9:
    buffer_load_dwordx2 v[120:121], v122, s[64:67], s92 offen sc1
    s_add_u32 s93, s93, 1
    s_waitcnt vmcnt(0)
    v_cmp_ne_u64 vcc, s[74:75], v[120:121]
    s_cmp_gt_u32 s93, 400000
    s_cbranch_scc1 WF_8
    s_and_b64 s[20:21], s[20:21], vcc
    s_cbranch_scc1 WP_9
WF_8:
    buffer_load_dword v160, v2, s[64:67], s76 offen offset:512
    buffer_load_dwordx4 v[128:131], v1, s[64:67], s76 offen
HOP_3:
    s_cbranch_execz HR_3
    s_add_u32 s76, s76, 2560
    ds_read_b64_tr_b16 a[122:123], v108 offset:24752
    v_exp_f32 v67, v67
    v_exp_f32 v68, v68
    v_exp_f32 v69, v69
    v_exp_f32 v70, v70
    buffer_load_dwordx4 v[132:135], v1, s[64:67], s76 offen
    s_add_u32 s76, s76, 2560
    v_exp_f32 v71, v71
    v_exp_f32 v72, v72
    v_exp_f32 v73, v73
    v_exp_f32 v74, v74
    v_exp_f32 v75, v75
    buffer_load_dwordx4 v[136:139], v1, s[64:67], s76 offen
    s_add_u32 s76, s76, 2560
    ds_read_b64_tr_b16 a[124:125], v108 offset:37008
    v_exp_f32 v76, v76
    v_exp_f32 v77, v77
    v_exp_f32 v78, v78
    v_exp_f32 v79, v79
    buffer_load_dwordx4 v[140:143], v1, s[64:67], s76 offen
    s_add_u32 s76, s76, 2560
    v_pk_add_f32 v[118:119], v[64:65], v[66:67]
    v_pk_add_f32 v[118:119], v[118:119], v[68:69]
    v_pk_add_f32 v[118:119], v[118:119], v[70:71]
    v_pk_add_f32 v[118:119], v[118:119], v[72:73]
    v_pk_add_f32 v[118:119], v[118:119], v[74:75]
    buffer_load_dword v161, v2, s[64:67], s76 offen offset:512
    v_pk_add_f32 v[118:119], v[118:119], v[76:77]
    ds_read_b64_tr_b16 a[126:127], v108 offset:37056
    v_pk_add_f32 v[118:119], v[118:119], v[78:79]
    v_add_f32 v118, v118, v119
    v_rcp_f32 v118, v118
    buffer_load_dwordx4 v[144:147], v1, s[64:67], s76 offen
    s_add_u32 s76, s76, 2560
    v_pk_mul_f32 v[64:65], v[64:65], v[118:119] op_sel_hi:[1,0]
    v_pk_mul_f32 v[66:67], v[66:67], v[118:119] op_sel_hi:[1,0]
    v_pk_mul_f32 v[68:69], v[68:69], v[118:119] op_sel_hi:[1,0]
    v_pk_mul_f32 v[70:71], v[70:71], v[118:119] op_sel_hi:[1,0]
    v_pk_mul_f32 v[72:73], v[72:73], v[118:119] op_sel_hi:[1,0]
    buffer_load_dwordx4 v[148:151], v1, s[64:67], s76 offen
    s_add_u32 s76, s76, 2560
    v_pk_mul_f32 v[74:75], v[74:75], v[118:119] op_sel_hi:[1,0]
    v_pk_mul_f32 v[76:77], v[76:77], v[118:119] op_sel_hi:[1,0]
    ds_read_b64_tr_b16 a[128:129], v127 offset:24736
    v_pk_mul_f32 v[78:79], v[78:79], v[118:119] op_sel_hi:[1,0]
    v_cvt_pk_bf16_f32 v16, v64, v65
    buffer_load_dwordx4 v[152:155], v1, s[64:67], s76 offen
    s_add_u32 s76, s76, 2560
    v_cvt_pk_bf16_f32 v17, v66, v67
    v_cvt_pk_bf16_f32 v18, v68, v69
    v_cvt_pk_bf16_f32 v19, v70, v71
    v_cvt_pk_bf16_f32 v20, v72, v73
    v_cvt_pk_bf16_f32 v21, v74, v75
    buffer_load_dwordx4 v[156:159], v1, s[64:67], s76 offen
    v_cvt_pk_bf16_f32 v22, v76, v77
    v_cvt_pk_bf16_f32 v23, v78, v79
    ds_read_b64_tr_b16 a[130:131], v127 offset:24784
    v_max3_f32 v118, v80, v81, v82
    v_max3_f32 v119, v83, v84, v85
    v_max3_f32 v118, v118, v86, v87
    v_max3_f32 v119, v119, v88, v89
    v_max3_f32 v118, v118, v90, v91
    v_max3_f32 v119, v119, v92, v93
    v_max3_f32 v118, v118, v94, v95
    v_max_f32 v118, v118, v119
    v_mul_f32 v118, v118, v116
    v_pk_fma_f32 v[80:81], v[80:81], v[116:117], v[118:119] op_sel_hi:[1,0,0] neg_lo:[0,0,1] neg_hi:[0,0,1]
    ds_read_b64_tr_b16 a[132:133], v108 offset:26240
    v_pk_fma_f32 v[82:83], v[82:83], v[116:117], v[118:119] op_sel_hi:[1,0,0] neg_lo:[0,0,1] neg_hi:[0,0,1]
    v_pk_fma_f32 v[84:85], v[84:85], v[116:117], v[118:119] op_sel_hi:[1,0,0] neg_lo:[0,0,1] neg_hi:[0,0,1]
    v_pk_fma_f32 v[86:87], v[86:87], v[116:117], v[118:119] op_sel_hi:[1,0,0] neg_lo:[0,0,1] neg_hi:[0,0,1]
    v_pk_fma_f32 v[88:89], v[88:89], v[116:117], v[118:119] op_sel_hi:[1,0,0] neg_lo:[0,0,1] neg_hi:[0,0,1]
    v_pk_fma_f32 v[90:91], v[90:91], v[116:117], v[118:119] op_sel_hi:[1,0,0] neg_lo:[0,0,1] neg_hi:[0,0,1]
    v_pk_fma_f32 v[92:93], v[92:93], v[116:117], v[118:119] op_sel_hi:[1,0,0] neg_lo:[0,0,1] neg_hi:[0,0,1]
    v_pk_fma_f32 v[94:95], v[94:95], v[116:117], v[118:119] op_sel_hi:[1,0,0] neg_lo:[0,0,1] neg_hi:[0,0,1]
    v_exp_f32 v80, v80
    v_exp_f32 v81, v81
    v_exp_f32 v82, v82
    ds_read_b64_tr_b16 a[134:135], v108 offset:26288
    v_exp_f32 v83, v83
    v_exp_f32 v84, v84
    v_exp_f32 v85, v85
    v_exp_f32 v86, v86
    v_exp_f32 v87, v87
    v_exp_f32 v88, v88
    v_exp_f32 v89, v89
    v_exp_f32 v90, v90
    v_exp_f32 v91, v91
    ds_read_b64_tr_b16 a[136:137], v108 offset:38544
    v_exp_f32 v92, v92
    v_exp_f32 v93, v93
    v_exp_f32 v94, v94
    v_exp_f32 v95, v95
    v_pk_add_f32 v[118:119], v[80:81], v[82:83]
    v_pk_add_f32 v[118:119], v[118:119], v[84:85]
    v_pk_add_f32 v[118:119], v[118:119], v[86:87]
    v_pk_add_f32 v[118:119], v[118:119], v[88:89]
    v_pk_add_f32 v[118:119], v[118:119], v[90:91]
    v_pk_add_f32 v[118:119], v[118:119], v[92:93]
    ds_read_b64_tr_b16 a[138:139], v108 offset:38592
    v_pk_add_f32 v[118:119], v[118:119], v[94:95]
    buffer_load_dwordx4 a[192:195], v13, s[64:67], s25 offen offset:0
    v_add_f32 v118, v118, v119
    v_rcp_f32 v118, v118
    s_nop 0
    v_pk_mul_f32 v[80:81], v[80:81], v[118:119] op_sel_hi:[1,0]
    buffer_load_dwordx4 a[196:199], v14, s[64:67], s25 offen offset:0
    v_pk_mul_f32 v[82:83], v[82:83], v[118:119] op_sel_hi:[1,0]
    v_pk_mul_f32 v[84:85], v[84:85], v[118:119] op_sel_hi:[1,0]
    v_pk_mul_f32 v[86:87], v[86:87], v[118:119] op_sel_hi:[1,0]
    buffer_load_dwordx4 a[200:203], v13, s[64:67], s25 offen offset:2048
    v_pk_mul_f32 v[88:89], v[88:89], v[118:119] op_sel_hi:[1,0]
    v_pk_mul_f32 v[90:91], v[90:91], v[118:119] op_sel_hi:[1,0]
    v_pk_mul_f32 v[92:93], v[92:93], v[118:119] op_sel_hi:[1,0]
    buffer_load_dwordx4 a[204:207], v14, s[64:67], s25 offen offset:2048
    s_add_u32 s25, s25, 4096
    ds_read_b64_tr_b16 a[140:141], v127 offset:26272
    v_pk_mul_f32 v[94:95], v[94:95], v[118:119] op_sel_hi:[1,0]
    v_cvt_pk_bf16_f32 v24, v80, v81
    buffer_load_dwordx4 a[208:211], v13, s[64:67], s25 offen offset:0
    v_cvt_pk_bf16_f32 v25, v82, v83
    v_cvt_pk_bf16_f32 v26, v84, v85
    v_cvt_pk_bf16_f32 v27, v86, v87
    buffer_load_dwordx4 a[212:215], v14, s[64:67], s25 offen offset:0
    v_cvt_pk_bf16_f32 v28, v88, v89
    v_cvt_pk_bf16_f32 v29, v90, v91
    v_cvt_pk_bf16_f32 v30, v92, v93
    buffer_load_dwordx4 a[216:219], v13, s[64:67], s25 offen offset:2048
    v_cvt_pk_bf16_f32 v31, v94, v95
    ds_read_b64_tr_b16 a[142:143], v127 offset:26320
    buffer_load_dwordx4 a[220:223], v14, s[64:67], s25 offen offset:2048
    s_add_u32 s25, s25, 4096
    v_and_b32 v122, 15, v0
    v_lshlrev_b32 v122, 3, v122
    s_waitcnt vmcnt(17)
    v_dot2c_f32_bf16 v184, v160, v6
    v_dot2c_f32_bf16 v185, v160, v7
    s_waitcnt vmcnt(16)
    v_dot2c_f32_bf16 v176, v128, v6
    v_dot2c_f32_bf16 v177, v128, v7
    v_dot2c_f32_bf16 v178, v129, v6
    v_dot2c_f32_bf16 v179, v129, v7
    v_dot2c_f32_bf16 v180, v130, v6
    v_dot2c_f32_bf16 v181, v130, v7
    v_dot2c_f32_bf16 v182, v131, v6
    v_dot2c_f32_bf16 v183, v131, v7
    s_waitcnt vmcnt(15)
    v_dot2c_f32_bf16 v176, v132, v6
    v_dot2c_f32_bf16 v177, v132, v7
    v_dot2c_f32_bf16 v178, v133, v6
    v_dot2c_f32_bf16 v179, v133, v7
    v_dot2c_f32_bf16 v180, v134, v6
    v_dot2c_f32_bf16 v181, v134, v7
    v_dot2c_f32_bf16 v182, v135, v6
    v_dot2c_f32_bf16 v183, v135, v7
    s_waitcnt vmcnt(14)
    v_dot2c_f32_bf16 v176, v136, v6
    v_dot2c_f32_bf16 v177, v136, v7
    v_dot2c_f32_bf16 v178, v137, v6
    buffer_load_dwordx4 a[224:227], v13, s[64:67], s25 offen offset:0
    v_dot2c_f32_bf16 v179, v137, v7
    v_dot2c_f32_bf16 v180, v138, v6
    v_dot2c_f32_bf16 v181, v138, v7
    v_dot2c_f32_bf16 v182, v139, v6
    v_dot2c_f32_bf16 v183, v139, v7
    s_waitcnt vmcnt(14)
    v_dot2c_f32_bf16 v176, v140, v6
    v_dot2c_f32_bf16 v177, v140, v7
    v_dot2c_f32_bf16 v178, v141, v6
    v_dot2c_f32_bf16 v179, v141, v7
    v_dot2c_f32_bf16 v180, v142, v6
    v_dot2c_f32_bf16 v181, v142, v7
    buffer_load_dwordx4 a[228:231], v14, s[64:67], s25 offen offset:0
    v_dot2c_f32_bf16 v182, v143, v6
    v_dot2c_f32_bf16 v183, v143, v7
    s_waitcnt vmcnt(14)
    v_dot2c_f32_bf16 v184, v161, v6
    v_dot2c_f32_bf16 v185, v161, v7
    s_waitcnt vmcnt(13)
    v_dot2c_f32_bf16 v176, v144, v6
    v_dot2c_f32_bf16 v177, v144, v7
    v_dot2c_f32_bf16 v178, v145, v6
    v_dot2c_f32_bf16 v179, v145, v7
    v_dot2c_f32_bf16 v180, v146, v6
    v_dot2c_f32_bf16 v181, v146, v7
    v_dot2c_f32_bf16 v182, v147, v6
    buffer_load_dwordx4 a[232:235], v13, s[64:67], s25 offen offset:2048
    v_dot2c_f32_bf16 v183, v147, v7
    s_waitcnt vmcnt(13)
    v_dot2c_f32_bf16 v176, v148, v6
    v_dot2c_f32_bf16 v177, v148, v7
    v_dot2c_f32_bf16 v178, v149, v6
    v_dot2c_f32_bf16 v179, v149, v7
    v_dot2c_f32_bf16 v180, v150, v6
    v_dot2c_f32_bf16 v181, v150, v7
    v_dot2c_f32_bf16 v182, v151, v6
    v_dot2c_f32_bf16 v183, v151, v7
    v_permlane16_swap_b32 v184, v185
    s_waitcnt vmcnt(12)
    v_dot2c_f32_bf16 v176, v152, v6
    buffer_load_dwordx4 a[236:239], v14, s[64:67], s25 offen offset:2048
    s_add_u32 s25, s25, 4096
    v_dot2c_f32_bf16 v177, v152, v7
    v_add_f32 v184, v184, v185
    v_dot2c_f32_bf16 v178, v153, v6
    v_dot2c_f32_bf16 v179, v153, v7
    v_mov_b32 v185, v184
    v_dot2c_f32_bf16 v180, v154, v6
    v_dot2c_f32_bf16 v181, v154, v7
    v_dot2c_f32_bf16 v182, v155, v6
    v_dot2c_f32_bf16 v183, v155, v7
    v_permlane32_swap_b32 v184, v185
    s_waitcnt vmcnt(12)
    v_dot2c_f32_bf16 v176, v156, v6
    buffer_load_dwordx4 a[240:243], v13, s[64:67], s25 offen offset:0
    v_dot2c_f32_bf16 v177, v156, v7
    v_add_f32 v184, v184, v185
    v_dot2c_f32_bf16 v178, v157, v6
    v_dot2c_f32_bf16 v179, v157, v7
    v_cvt_pk_bf16_f32 v184, v184, v184
    v_dot2c_f32_bf16 v180, v158, v6
    v_dot2c_f32_bf16 v181, v158, v7
    ds_write_b16 v4, v184 offset:512
    v_dot2c_f32_bf16 v182, v159, v6
    v_dot2c_f32_bf16 v183, v159, v7
    buffer_load_dwordx4 a[244:247], v14, s[64:67], s25 offen offset:0
    v_cvt_pk_bf16_f32 v176, v176, v177
    v_cvt_pk_bf16_f32 v177, v178, v179
    v_cvt_pk_bf16_f32 v178, v180, v181
    v_cvt_pk_bf16_f32 v179, v182, v183
    ds_write_b128 v3, v[176:179]
    s_waitcnt lgkmcnt(0)
    s_barrier
    ds_read_b128 v[128:131], v5 offset:0
    ds_read_b128 v[132:135], v5 offset:1088
    ds_read_b128 v[136:139], v5 offset:16
    ds_read_b128 v[140:143], v5 offset:1104
    ds_read_b128 v[144:147], v5 offset:2176
    ds_read_b128 v[148:151], v5 offset:3264
    ds_read_b128 v[152:155], v5 offset:2192
    ds_read_b128 v[156:159], v5 offset:3280
    buffer_load_dwordx4 a[248:251], v13, s[64:67], s25 offen offset:2048
    buffer_load_dwordx4 a[252:255], v14, s[64:67], s25 offen offset:2048
    s_add_u32 s25, s25, 4096
    s_waitcnt lgkmcnt(7)
    v_mfma_f32_32x32x16_bf16 v[64:79], v[128:131], v[16:19], 0
    s_waitcnt lgkmcnt(6)
    v_mfma_f32_32x32x16_bf16 v[80:95], v[132:135], v[24:27], 0
    s_waitcnt lgkmcnt(5)
    v_mfma_f32_32x32x16_bf16 v[64:79], v[136:139], v[20:23], v[64:79]
    s_waitcnt lgkmcnt(4)
    v_mfma_f32_32x32x16_bf16 v[80:95], v[140:143], v[28:31], v[80:95]
    s_waitcnt lgkmcnt(3)
    v_mfma_f32_32x32x16_bf16 v[64:79], v[144:147], v[16:19], v[64:79]
    s_waitcnt lgkmcnt(2)
    v_mfma_f32_32x32x16_bf16 v[80:95], v[148:151], v[24:27], v[80:95]
    s_waitcnt lgkmcnt(1)
    v_mfma_f32_32x32x16_bf16 v[64:79], v[152:155], v[20:23], v[64:79]
    s_waitcnt lgkmcnt(0)
    v_mfma_f32_32x32x16_bf16 v[80:95], v[156:159], v[28:31], v[80:95]
    s_nop 9
    v_add_f32 v68, 0x358637bd, v68
    v_rcp_f32 v68, v68
    s_nop 0
    v_pk_mul_f32 v[64:65], v[64:65], v[68:69] op_sel_hi:[1,0]
    v_pk_mul_f32 v[66:67], v[66:67], v[68:69] op_sel_hi:[1,0]
    v_pk_mul_f32 v[72:73], v[72:73], v[68:69] op_sel_hi:[1,0]
    v_pk_mul_f32 v[74:75], v[74:75], v[68:69] op_sel_hi:[1,0]
    v_cvt_pk_bf16_f32 v76, v64, v65
    v_cvt_pk_bf16_f32 v77, v66, v67
    v_cvt_pk_bf16_f32 v78, v72, v73
    v_cvt_pk_bf16_f32 v79, v74, v75
    buffer_store_dwordx4 v[76:79], v12, s[64:67], s78 offen offset:0 sc1
    v_add_f32 v84, 0x358637bd, v84
    v_rcp_f32 v84, v84
    s_nop 0
    v_pk_mul_f32 v[80:81], v[80:81], v[84:85] op_sel_hi:[1,0]
    v_pk_mul_f32 v[82:83], v[82:83], v[84:85] op_sel_hi:[1,0]
    v_pk_mul_f32 v[88:89], v[88:89], v[84:85] op_sel_hi:[1,0]
    v_pk_mul_f32 v[90:91], v[90:91], v[84:85] op_sel_hi:[1,0]
    v_cvt_pk_bf16_f32 v92, v80, v81
    v_cvt_pk_bf16_f32 v93, v82, v83
    v_cvt_pk_bf16_f32 v94, v88, v89
    v_cvt_pk_bf16_f32 v95, v90, v91
    buffer_store_dwordx4 v[92:95], v12, s[64:67], s78 offen offset:1024 sc1
    s_min_u32 s92, s68, 2
    s_lshr_b32 s93, s70, 3
    s_lshl4_add_u32 s93, s93, s69
    s_mul_i32 s93, s93, 3
    s_add_u32 s93, s93, s92
    s_lshl_b32 s93, s93, 14
    s_and_b32 s94, s70, 7
    s_lshl_b32 s94, s94, 7
    s_add_u32 s93, s93, s94
    v_lshrrev_b32 v40, 3, v0
    v_and_b32 v41, 7, v0
    v_lshlrev_b32 v41, 4, v41
    v_lshl_add_u32 v40, v40, 10, v41
    v_add_u32 v40, s93, v40
    v_add_u32 v41, 8192, v40
    s_lshl_b32 s13, s92, 11
    s_add_u32 s13, s13, 157696
    s_mov_b32 m0, s13
    s_nop 0
    buffer_load_dwordx4 v40, s[52:55], 0 offen lds
    s_add_u32 m0, s13, 1024
    s_nop 0
    buffer_load_dwordx4 v41, s[52:55], 0 offen lds
    v_bfe_u32 v42, v0, 2, 2
    v_lshrrev_b32 v43, 5, v0
    v_lshl_add_u32 v42, v43, 3, v42
    v_lshlrev_b32 v42, 7, v42
    v_bfe_u32 v43, v0, 4, 1
    v_lshl_add_u32 v42, v43, 5, v42
    v_and_b32 v43, 3, v0
    v_lshl_add_u32 v42, v43, 3, v42
    v_add_u32 v42, s13, v42
    s_cmp_eq_u32 s68, 3
    s_cselect_b32 s92, 268435456, 0
    v_or_b32 v43, s92, v12
    s_xor_b32 s96, s68, 1
    s_mul_i32 s96, s96, 6144
    s_add_u32 s96, s96, 51200
    v_add_u32 v1, s96, v12
    s_xor_b32 s96, s68, 2
    s_mul_i32 s96, s96, 6144
    s_add_u32 s96, s96, 53248
    v_add_u32 v2, s96, v12
    s_xor_b32 s96, s68, 3
    s_mul_i32 s96, s96, 6144
    s_add_u32 s96, s96, 55296
    v_add_u32 v3, s96, v12
    s_mul_i32 s96, s68, 6144
    s_add_u32 s96, s96, 51200
    v_add_u32 v4, s96, v12
    v_mov_b32 v120, s18
    v_mov_b32 v121, s19
    v_lshlrev_b32 v122, 10, v0
    s_and_b32 s79, s68, 2
    s_add_u32 s79, s79, s27
    s_xor_b32 s78, s79, 2
    s_lshl2_add_u32 s78, s78, s68
    s_lshl_b32 s78, s78, 13
    s_and_b32 s96, s70, 7
    s_and_b32 s97, s68, 1
    s_lshl1_add_u32 s96, s96, s97
    s_lshl4_add_u32 s79, s79, s96
    s_lshl_b32 s80, s79, 8
    s_add_u32 s80, s80, 11534336
    s_lshl_b32 s79, s79, 11
    s_add_u32 s79, s79, 2097152
    s_lshr_b32 s96, s68, 1
    s_lshl2_add_u32 s81, s96, s97
    s_lshl_b32 s81, s81, 8
    v_lshlrev_b32 v5, 2, v0
    v_mov_b32 v104, 0
    v_mov_b32 v105, 0
    v_mov_b32 v106, 0
    v_mov_b32 v107, 0
    s_cmp_eq_u32 s68, 0
    s_cbranch_scc1 HS_10
    s_mov_b64 exec, 0
    s_cmp_eq_u32 s68, 1
    s_cbranch_scc1 HOP_4
    s_cmp_eq_u32 s68, 2
    s_cbranch_scc1 HOP_5
    s_branch HOP_6
HR_11:
    s_mov_b64 exec, -1
HS_10:
    s_waitcnt vmcnt(2)
    s_mov_b64 exec, 0xffff
    buffer_store_dwordx2 v[120:121], v122, s[64:67], s16 offen
    s_mov_b64 exec, -1
    v_add_u32 v127, 123520, v127
    v_add_u32 v108, 123520, v108
    ds_read_b64_tr_b16 a[144:145], v108 offset:0
    ds_read_b64_tr_b16 a[146:147], v108 offset:48
    ds_read_b64_tr_b16 a[148:149], v108 offset:12304
    ds_read_b64_tr_b16 a[150:151], v108 offset:12352
    ds_read_b64_tr_b16 a[152:153], v127 offset:32
    ds_read_b64_tr_b16 a[154:155], v127 offset:80
    ds_read_b64_tr_b16 a[156:157], v108 offset:1536
    ds_read_b64_tr_b16 a[158:159], v108 offset:1584
    ds_read_b64_tr_b16 a[160:161], v108 offset:13840
    ds_read_b64_tr_b16 a[162:163], v108 offset:13888
    ds_read_b64_tr_b16 a[164:165], v127 offset:1568
    ds_read_b64_tr_b16 a[166:167], v127 offset:1616
    s_add_u32 s9, s7, 176128
    s_add_u32 m0, s8, 0
    s_nop 0
    buffer_load_dwordx4 v123, s[44:47], s9 offen offset:0 lds
    s_add_u32 m0, s8, 0
    s_nop 0
    buffer_load_dwordx4 v124, s[44:47], s9 offen offset:1024 lds
    s_add_u32 m0, s8, 0
    s_nop 0
    buffer_load_dwordx4 v125, s[44:47], s9 offen offset:2048 lds
    s_add_u32 m0, s8, 12304
    s_nop 0
    buffer_load_dwordx4 v123, s[48:51], s9 offen offset:0 lds
    s_add_u32 m0, s8, 12304
    s_nop 0
    buffer_load_dwordx4 v124, s[48:51], s9 offen offset:1024 lds
    s_add_u32 m0, s8, 12304
    s_nop 0
    buffer_load_dwordx4 v125, s[48:51], s9 offen offset:2048 lds
    s_lshr_b32 s92, s70, 3
    s_lshl2_add_u32 s92, s92, s68
    s_lshl_b32 s92, s92, 6
    s_xor_b32 s92, s92, 128
    s_waitcnt lgkmcnt(0)
    s_add_u32 s93, s92, s15
    s_add_u32 s94, s93, 16384
SP_13:
    s_buffer_load_dwordx16 s[28:43], s[64:67], s93
    s_add_u32 s93, s93, 1024
    s_cmp_gt_u32 s93, s94
    s_cbranch_scc1 SX_15
    s_waitcnt lgkmcnt(0)
    s_xor_b64 s[28:29], s[28:29], s[18:19]
    s_xor_b64 s[30:31], s[30:31], s[18:19]
    s_xor_b64 s[32:33], s[32:33], s[18:19]
    s_xor_b64 s[34:35], s[34:35], s[18:19]
    s_xor_b64 s[36:37], s[36:37], s[18:19]
    s_xor_b64 s[38:39], s[38:39], s[18:19]
    s_xor_b64 s[40:41], s[40:41], s[18:19]
    s_xor_b64 s[42:43], s[42:43], s[18:19]
    s_or_b64 s[28:29], s[28:29], s[30:31]
    s_or_b64 s[32:33], s[32:33], s[34:35]
    s_or_b64 s[36:37], s[36:37], s[38:39]
    s_or_b64 s[40:41], s[40:41], s[42:43]
    s_or_b64 s[28:29], s[28:29], s[32:33]
    s_or_b64 s[36:37], s[36:37], s[40:41]
    s_or_b64 s[28:29], s[28:29], s[36:37]
    s_cbranch_scc1 SP_13
SD_12:
    buffer_load_dwordx4 v[128:131], v12, s[64:67], s78 offen offset:0
    buffer_load_dwordx4 v[132:135], v12, s[64:67], s78 offen offset:1024
    buffer_load_dwordx4 v[136:139], v12, s[64:67], s78 offen offset:2048
    buffer_load_dwordx4 v[140:143], v12, s[64:67], s78 offen offset:3072
    s_add_u32 s78, s78, 4096
    buffer_load_dwordx4 v[144:147], v12, s[64:67], s78 offen offset:0
    buffer_load_dwordx4 v[148:151], v12, s[64:67], s78 offen offset:1024
    buffer_load_dwordx4 v[152:155], v12, s[64:67], s78 offen offset:2048
    buffer_load_dwordx4 v[156:159], v12, s[64:67], s78 offen offset:3072
    s_xor_b32 s78, s78, 69632
    v_mov_b32 v76, v109
    v_mov_b32 v77, v109
    v_mov_b32 v78, v109
    v_mov_b32 v79, v109
    s_nop 1
    v_mfma_f32_16x16x32_bf16 v[64:67], a[72:75], v[76:79], 0
    v_mfma_f32_16x16x32_bf16 v[68:71], a[76:79], v[76:79], 0
    buffer_load_dwordx4 v[160:163], v12, s[64:67], s78 offen offset:0
    v_mfma_f32_16x16x32_bf16 v[72:75], a[80:83], v[76:79], 0
    v_lshrrev_b32 v110, 5, v0
    v_mfma_f32_16x16x32_bf16 v[64:67], a[84:87], v[76:79], v[64:67]
    buffer_load_dwordx4 v[164:167], v12, s[64:67], s78 offen offset:1024
    v_mfma_f32_16x16x32_bf16 v[68:71], a[88:91], v[76:79], v[68:71]
    v_lshl_or_b32 v112, v110, 11, s81
    v_mfma_f32_16x16x32_bf16 v[72:75], a[92:95], v[76:79], v[72:75]
    v_bfe_u32 v110, v0, 4, 1
    v_mfma_f32_16x16x32_bf16 v[64:67], a[96:99], v[76:79], v[64:67]
    buffer_load_dwordx4 v[168:171], v12, s[64:67], s78 offen offset:2048
    v_mfma_f32_16x16x32_bf16 v[68:71], a[100:103], v[76:79], v[68:71]
    v_lshl_or_b32 v112, v110, 9, v112
    v_mfma_f32_16x16x32_bf16 v[72:75], a[104:107], v[76:79], v[72:75]
    v_bfe_u32 v110, v0, 3, 1
    v_mfma_f32_16x16x32_bf16 v[64:67], a[108:111], v[76:79], v[64:67]
    buffer_load_dwordx4 v[172:175], v12, s[64:67], s78 offen offset:3072
    s_add_u32 s78, s78, 4096
    v_mfma_f32_16x16x32_bf16 v[68:71], a[112:115], v[76:79], v[68:71]
    v_lshl_or_b32 v112, v110, 6, v112
    v_mfma_f32_16x16x32_bf16 v[72:75], a[116:119], v[76:79], v[72:75]
    v_bfe_u32 v110, v0, 2, 1
    v_mfma_f32_16x16x32_bf16 v[64:67], a[120:123], v[76:79], v[64:67]
    v_mfma_f32_16x16x32_bf16 v[68:71], a[124:127], v[76:79], v[68:71]
    buffer_load_dwordx4 v[176:179], v12, s[64:67], s78 offen offset:0
    v_mfma_f32_16x16x32_bf16 v[72:75], a[128:131], v[76:79], v[72:75]
    v_lshl_or_b32 v112, v110, 7, v112
    v_mfma_f32_16x16x32_bf16 v[64:67], a[132:135], v[76:79], v[64:67]
    buffer_load_dwordx4 v[180:183], v12, s[64:67], s78 offen offset:1024
    v_mfma_f32_16x16x32_bf16 v[68:71], a[136:139], v[76:79], v[68:71]
    v_and_b32 v110, 3, v0
    v_mfma_f32_16x16x32_bf16 v[72:75], a[140:143], v[76:79], v[72:75]
    v_lshl_or_b32 v13, v110, 4, v112
    v_mfma_f32_16x16x32_bf16 v[64:67], a[144:147], v[76:79], v[64:67]
    buffer_load_dwordx4 v[184:187], v12, s[64:67], s78 offen offset:2048
    v_mfma_f32_16x16x32_bf16 v[68:71], a[148:151], v[76:79], v[68:71]
    v_xor_b32 v14, 256, v13
    v_mfma_f32_16x16x32_bf16 v[72:75], a[152:155], v[76:79], v[72:75]
    v_xor_b32 v112, 1024, v13
    v_mfma_f32_16x16x32_bf16 v[64:67], a[156:159], v[76:79], v[64:67]
    buffer_load_dwordx4 v[188:191], v12, s[64:67], s78 offen offset:3072
    v_mfma_f32_16x16x32_bf16 v[68:71], a[160:163], v[76:79], v[68:71]
    v_xor_b32 v113, 1280, v13
    v_mfma_f32_16x16x32_bf16 v[72:75], a[164:167], v[76:79], v[72:75]
    s_cmp_eq_u32 s68, 3
    s_cselect_b32 s91, 0, 4096
    s_waitcnt vmcnt(15)
    v_mfma_f32_32x32x16_bf16 v[192:207], a[192:195], v[128:131], 0
    ds_read_b64_tr_b16 v[44:45], v42 offset:0
    v_mfma_f32_32x32x16_bf16 v[208:223], a[196:199], v[128:131], 0
    ds_read_b64_tr_b16 v[46:47], v42 offset:512
    s_waitcnt vmcnt(14)
    v_mfma_f32_32x32x16_bf16 v[192:207], a[200:203], v[132:135], v[192:207]
    ds_read_b64_tr_b16 v[48:49], v42 offset:64
    v_mfma_f32_32x32x16_bf16 v[208:223], a[204:207], v[132:135], v[208:223]
    ds_read_b64_tr_b16 v[50:51], v42 offset:576
    s_waitcnt vmcnt(13)
    v_mfma_f32_32x32x16_bf16 v[192:207], a[208:211], v[136:139], v[192:207]
    v_add_u32 v127, -123520, v127
    v_add_u32 v108, -123520, v108
    ds_read_b64_tr_b16 a[168:169], v108 offset:0
    v_mfma_f32_32x32x16_bf16 v[208:223], a[212:215], v[136:139], v[208:223]
    ds_read_b64_tr_b16 a[170:171], v108 offset:48
    ds_read_b64_tr_b16 a[172:173], v108 offset:12304
    s_waitcnt vmcnt(12)
    v_mfma_f32_32x32x16_bf16 v[192:207], a[216:219], v[140:143], v[192:207]
    ds_read_b64_tr_b16 a[174:175], v108 offset:12352
    v_mfma_f32_32x32x16_bf16 v[208:223], a[220:223], v[140:143], v[208:223]
    ds_read_b64_tr_b16 a[176:177], v127 offset:32
    s_waitcnt vmcnt(11)
    v_mfma_f32_32x32x16_bf16 v[192:207], a[224:227], v[144:147], v[192:207]
    ds_read_b64_tr_b16 a[178:179], v127 offset:80
    v_mfma_f32_32x32x16_bf16 v[208:223], a[228:231], v[144:147], v[208:223]
    ds_read_b64_tr_b16 a[180:181], v108 offset:1536
    s_waitcnt vmcnt(10)
    v_mfma_f32_32x32x16_bf16 v[192:207], a[232:235], v[148:151], v[192:207]
    ds_read_b64_tr_b16 a[182:183], v108 offset:1584
    ds_read_b64_tr_b16 a[184:185], v108 offset:13840
    v_mfma_f32_32x32x16_bf16 v[208:223], a[236:239], v[148:151], v[208:223]
    ds_read_b64_tr_b16 a[186:187], v108 offset:13888
    s_waitcnt vmcnt(9)
    v_mfma_f32_32x32x16_bf16 v[192:207], a[240:243], v[152:155], v[192:207]
    ds_read_b64_tr_b16 a[188:189], v127 offset:1568
    v_mfma_f32_32x32x16_bf16 v[208:223], a[244:247], v[152:155], v[208:223]
    ds_read_b64_tr_b16 a[190:191], v127 offset:1616
    s_waitcnt vmcnt(8)
    v_mfma_f32_32x32x16_bf16 v[192:207], a[248:251], v[156:159], v[192:207]
    s_add_u32 m0, s8, 24704
    s_nop 0
    buffer_load_dwordx4 v123, s[44:47], s4 offen offset:0 lds
    v_mfma_f32_32x32x16_bf16 v[208:223], a[252:255], v[156:159], v[208:223]
    s_add_u32 m0, s8, 24704
    s_nop 0
    buffer_load_dwordx4 v124, s[44:47], s4 offen offset:1024 lds
    s_add_u32 m0, s8, 24704
    s_nop 0
    buffer_load_dwordx4 v125, s[44:47], s4 offen offset:2048 lds
    s_waitcnt vmcnt(10)
    v_mfma_f32_32x32x16_bf16 v[224:239], a[192:195], v[160:163], v[224:239]
    v_mfma_f32_32x32x16_bf16 v[240:255], a[196:199], v[160:163], 0
    s_waitcnt vmcnt(9)
    v_mfma_f32_32x32x16_bf16 v[224:239], a[200:203], v[164:167], v[224:239]
    ds_write_b128 v2, v[192:195] offset:0
    v_mfma_f32_32x32x16_bf16 v[240:255], a[204:207], v[164:167], v[240:255]
    ds_write_b128 v2, v[196:199] offset:1024
    s_waitcnt vmcnt(8)
    v_mfma_f32_32x32x16_bf16 v[224:239], a[208:211], v[168:171], v[224:239]
    ds_write_b128 v2, v[200:203] offset:24576
    v_mfma_f32_32x32x16_bf16 v[240:255], a[212:215], v[168:171], v[240:255]
    s_waitcnt lgkmcnt(15)
    buffer_store_dwordx4 v[44:47], v43, s[64:67], s10 offen offset:0 sc1
    ds_write_b128 v2, v[204:207] offset:25600
    s_waitcnt vmcnt(8)
    v_mfma_f32_32x32x16_bf16 v[224:239], a[216:219], v[172:175], v[224:239]
    ds_write_b128 v3, v[208:211] offset:0
    buffer_store_dwordx4 v[48:51], v43, s[64:67], s10 offen offset:1024 sc1
    v_mfma_f32_32x32x16_bf16 v[240:255], a[220:223], v[172:175], v[240:255]
    ds_write_b128 v3, v[212:215] offset:1024
    s_waitcnt vmcnt(8)
    v_mfma_f32_32x32x16_bf16 v[240:255], a[228:231], v[176:179], v[240:255]
    s_add_u32 m0, s8, 37008
    s_nop 0
    buffer_load_dwordx4 v123, s[48:51], s4 offen offset:0 lds
    ds_write_b128 v3, v[216:219] offset:24576
    s_waitcnt vmcnt(8)
    v_mfma_f32_32x32x16_bf16 v[240:255], a[236:239], v[180:183], v[240:255]
    ds_write_b128 v3, v[220:223] offset:25600
    s_add_u32 m0, s8, 37008
    s_nop 0
    buffer_load_dwordx4 v124, s[48:51], s4 offen offset:1024 lds
    s_waitcnt vmcnt(8)
    v_mfma_f32_32x32x16_bf16 v[240:255], a[244:247], v[184:187], v[240:255]
    s_waitcnt vmcnt(7)
    v_mfma_f32_32x32x16_bf16 v[240:255], a[252:255], v[188:191], v[240:255]
    v_mfma_f32_32x32x16_bf16 v[224:239], a[224:227], v[176:179], v[224:239]
    s_add_u32 m0, s8, 37008
    s_nop 0
    buffer_load_dwordx4 v125, s[48:51], s4 offen offset:2048 lds
    s_nop 7
    ds_write_b128 v1, v[240:243] offset:0
    ds_write_b128 v1, v[244:247] offset:1024
    ds_write_b128 v1, v[248:251] offset:24576
    ds_write_b128 v1, v[252:255] offset:25600
    v_mfma_f32_32x32x16_bf16 v[224:239], a[232:235], v[180:183], v[224:239]
    v_mfma_f32_32x32x16_bf16 v[224:239], a[240:243], v[184:187], v[224:239]
    s_waitcnt lgkmcnt(0)
    s_barrier
    ds_read_b128 v[128:131], v4 offset:0
    ds_read_b128 v[132:135], v4 offset:1024
    ds_read_b128 v[136:139], v4 offset:2048
    v_mfma_f32_32x32x16_bf16 v[224:239], a[248:251], v[188:191], v[224:239]
    ds_read_b128 v[140:143], v4 offset:3072
    ds_read_b128 v[144:147], v4 offset:4096
    ds_read_b128 v[148:151], v4 offset:5120
    ds_read_b128 v[152:155], v4 offset:24576
    ds_read_b128 v[156:159], v4 offset:25600
    ds_read_b128 v[160:163], v4 offset:26624
    ds_read_b128 v[164:167], v4 offset:27648
    ds_read_b128 v[168:171], v4 offset:28672
    ds_read_b128 v[172:175], v4 offset:29696
    s_waitcnt lgkmcnt(11)
    s_nop 1
    v_pk_add_f32 v[224:225], v[224:225], v[128:129]
    v_pk_add_f32 v[226:227], v[226:227], v[130:131]
    s_waitcnt lgkmcnt(10)
    v_pk_add_f32 v[228:229], v[228:229], v[132:133]
    v_pk_add_f32 v[230:231], v[230:231], v[134:135]
    s_waitcnt lgkmcnt(9)
    v_pk_add_f32 v[224:225], v[224:225], v[136:137]
    v_pk_add_f32 v[226:227], v[226:227], v[138:139]
    s_waitcnt lgkmcnt(8)
    v_pk_add_f32 v[228:229], v[228:229], v[140:141]
    v_pk_add_f32 v[230:231], v[230:231], v[142:143]
    s_waitcnt lgkmcnt(7)
    v_pk_add_f32 v[224:225], v[224:225], v[144:145]
    v_pk_add_f32 v[226:227], v[226:227], v[146:147]
    s_waitcnt lgkmcnt(6)
    v_pk_add_f32 v[228:229], v[228:229], v[148:149]
    v_pk_add_f32 v[230:231], v[230:231], v[150:151]
    v_cvt_pk_bf16_f32 v96, v224, v225
    v_cvt_pk_bf16_f32 v97, v226, v227
    v_cvt_pk_bf16_f32 v98, v228, v229
    v_cvt_pk_bf16_f32 v99, v230, v231
    buffer_store_dwordx4 v[96:99], v12, s[64:67], s79 offen offset:0 sc1
    s_waitcnt lgkmcnt(5)
    v_pk_add_f32 v[232:233], v[232:233], v[152:153]
    v_pk_add_f32 v[234:235], v[234:235], v[154:155]
    s_waitcnt lgkmcnt(4)
    v_pk_add_f32 v[236:237], v[236:237], v[156:157]
    v_pk_add_f32 v[238:239], v[238:239], v[158:159]
    s_waitcnt lgkmcnt(3)
    v_pk_add_f32 v[232:233], v[232:233], v[160:161]
    v_pk_add_f32 v[234:235], v[234:235], v[162:163]
    s_waitcnt lgkmcnt(2)
    v_pk_add_f32 v[236:237], v[236:237], v[164:165]
    v_pk_add_f32 v[238:239], v[238:239], v[166:167]
    s_waitcnt lgkmcnt(1)
    v_pk_add_f32 v[232:233], v[232:233], v[168:169]
    v_pk_add_f32 v[234:235], v[234:235], v[170:171]
    s_waitcnt lgkmcnt(0)
HOP_4:
    s_cbranch_execz HR_11
    v_pk_add_f32 v[236:237], v[236:237], v[172:173]
    v_pk_add_f32 v[238:239], v[238:239], v[174:175]
    v_cvt_pk_bf16_f32 v100, v232, v233
    v_cvt_pk_bf16_f32 v101, v234, v235
    v_cvt_pk_bf16_f32 v102, v236, v237
    v_cvt_pk_bf16_f32 v103, v238, v239
    buffer_store_dwordx4 v[100:103], v12, s[64:67], s79 offen offset:1024 sc1
    v_dot2c_f32_bf16 v104, v96, v109
    v_dot2c_f32_bf16 v105, v96, v96
    v_dot2c_f32_bf16 v106, v100, v109
    v_dot2c_f32_bf16 v107, v100, v100
    v_dot2c_f32_bf16 v104, v97, v109
    v_dot2c_f32_bf16 v105, v97, v97
    v_dot2c_f32_bf16 v106, v101, v109
    v_dot2c_f32_bf16 v107, v101, v101
    v_dot2c_f32_bf16 v104, v98, v109
    v_dot2c_f32_bf16 v105, v98, v98
    v_dot2c_f32_bf16 v106, v102, v109
    v_dot2c_f32_bf16 v107, v102, v102
    v_dot2c_f32_bf16 v104, v99, v109
    v_dot2c_f32_bf16 v105, v99, v99
    v_dot2c_f32_bf16 v106, v103, v109
    v_dot2c_f32_bf16 v107, v103, v103
    s_nop 2
    v_pk_add_f32 v[104:105], v[104:105], v[106:107]
    s_nop 1
    v_permlane32_swap_b32 v104, v105
    v_add_f32 v104, v104, v105
    buffer_store_dword v104, v5, s[64:67], s80 offen sc1
    v_lshrrev_b32 v110, 4, v0
    v_and_b32 v111, 15, v0
    v_lshlrev_b32 v8, 4, v111
    v_lshl_add_u32 v6, v110, 9, v8
    v_add_u32 v7, 65536, v6
    v_lshlrev_b32 v9, 2, v111
    v_add_u32 v9, 131072, v9
    v_and_b32 v111, 7, v0
    v_lshl_add_u32 v110, v111, 2, v110
    s_lshl_b32 s96, s68, 7
    s_add_u32 s96, s96, 131072
    v_lshl_add_u32 v10, v110, 2, s96
    s_lshr_b32 s96, s68, 1
    s_and_b32 s97, s68, 1
    s_lshl_b32 s80, s96, 15
    s_lshl_b32 s97, s97, 12
    s_add_u32 s80, s80, s97
    s_lshl_b32 s96, s69, 17
    s_add_u32 s96, s96, s80
    s_add_u32 s96, s96, 2097152
    s_add_u32 s9, s4, 176128
    s_add_u32 m0, s8, 132096
    s_nop 0
    buffer_load_dwordx4 v123, s[44:47], s9 offen offset:0 lds
    s_add_u32 s97, s24, 0
    s_and_b32 s97, s97, 3
    s_lshl_b32 s97, s97, 13
    s_add_u32 s76, s96, s97
    s_add_u32 s97, s24, 1
    s_and_b32 s97, s97, 3
    s_lshl_b32 s97, s97, 13
    s_add_u32 s77, s96, s97
    s_add_u32 s97, s24, 2
    s_and_b32 s97, s97, 3
    s_lshl_b32 s97, s97, 13
    s_add_u32 s78, s96, s97
    s_add_u32 s97, s24, 3
    s_and_b32 s97, s97, 3
    s_lshl_b32 s97, s97, 13
    s_add_u32 s79, s96, s97
    s_lshl2_add_u32 s81, s69, s68
    s_lshl_b32 s81, s81, 12
    s_add_u32 s81, s81, 11534336
    s_mul_i32 s82, s69, 352256
    s_add_u32 m0, s8, 132096
    s_nop 0
    buffer_load_dwordx4 v124, s[44:47], s9 offen offset:1024 lds
    s_lshl2_add_u32 s96, s70, s68
    s_mul_i32 s96, s96, 1536
    s_add_u32 s82, s82, s96
    s_add_u32 s82, s82, 4194304
    s_add_u32 s87, s82, 176128
    s_mul_i32 s83, s27, 88064
    s_mul_i32 s96, s68, 22528
    s_add_u32 s83, s83, s96
    s_add_u32 s83, s83, 4194304
    s_add_u32 s84, s83, 176128
    v_lshrrev_b32 v110, 5, v0
    s_lshl2_add_u32 s96, s70, s68
    s_mul_i32 s96, s96, 3
    s_sub_u32 s97, 172, s96
    v_cmp_gt_i32 vcc, s97, v110
    v_bfe_u32 v111, v0, 4, 1
    v_mul_u32_u24 v105, 88064, v111
    v_add_u32 v105, v105, v8
    v_lshl_add_u32 v104, v110, 9, v105
    v_mov_b32 v106, 268435456
    s_add_u32 m0, s8, 132096
    s_nop 0
    buffer_load_dwordx4 v125, s[44:47], s9 offen offset:2048 lds
    v_cndmask_b32 v104, v106, v104, vcc
    v_lshl_add_u32 v105, v110, 3, v105
    s_cmp_lt_u32 s96, 170
    s_cselect_b32 s97, 0, 268435456
    v_or_b32 v105, s97, v105
    v_lshlrev_b32 v11, 6, v8
    v_lshl_add_u32 v11, v110, 14, v11
    v_lshl_add_u32 v11, v111, 4, v11
    s_cmp_eq_u32 s68, 3
    s_cselect_b32 s96, 268435456, 0
    v_or_b32 v114, s96, v6
    s_lshr_b32 s96, s70, 3
    s_lshl_b32 s96, s96, 7
    s_add_u32 s96, s96, 512
    v_add_u32 v8, s96, v9
    s_and_b32 s96, s70, 7
    s_lshl2_add_u32 s96, s96, s68
    s_lshl_b32 s96, s96, 5
    s_lshl_b32 s88, s27, 15
    s_add_u32 s88, s88, s96
    s_add_u32 s89, s88, 65536
    s_mov_b32 s90, s84
    s_lshl_b32 s10, s69, 11
    s_add_u32 s10, s10, 13008896
    s_lshl2_add_u32 s14, s70, s68
    s_lshl3_add_u32 s14, s14, s10
    v_cmp_eq_u32 vcc, 0, v0
    s_nop 1
    v_cndmask_b32 v5, v106, v0, vcc
    s_mul_i32 s96, s68, 1922404
    s_add_u32 s97, s96, 1878713
    s_lshr_b32 s96, s96, 17
    s_lshr_b32 s97, s97, 17
    s_min_u32 s97, s97, 57
    v_and_b32 v15, 15, v0
    v_add_u32 v15, s96, v15
    v_min_u32 v15, s97, v15
    v_lshlrev_b32 v15, 3, v15
    v_mov_b32 v106, s18
    v_mov_b32 v107, s19
    v_and_b32 v115, 31, v0
    v_lshlrev_b32 v115, 3, v115
    s_and_b32 s85, s70, 7
    s_lshl_b32 s85, s85, 8
    s_add_u32 s85, s85, 12605440
    s_mov_b32 s96, 0
    s_add_u32 s52, s96, 0
    s_and_b32 s52, s52, 3
    s_lshl_b32 s52, s52, 12
    s_add_u32 s53, s96, 1
    s_and_b32 s53, s53, 3
    s_lshl_b32 s53, s53, 12
    s_add_u32 s54, s96, 2
    s_and_b32 s54, s54, 3
    s_lshl_b32 s54, s54, 12
    s_add_u32 s55, s96, 3
    s_and_b32 s55, s55, 3
    s_lshl_b32 s55, s55, 12
    s_lshl1_add_u32 s12, s52, s26
    s_add_u32 s13, s52, s83
    s_bfe_u32 s96, s70, 0x20001
    s_sub_u32 s96, s96, s24
    s_and_b32 s96, s96, 3
    s_lshr_b32 s97, s70, 3
    s_lshl2_add_u32 s96, s97, s96
    s_and_b32 s97, s70, 1
    s_lshl1_add_u32 s96, s96, s97
    s_lshl2_add_u32 s96, s96, s68
    s_lshl_b32 s86, s96, 10
    s_waitcnt vmcnt(6)
    ds_read_b64_tr_b16 a[0:1], v108 offset:24704
    ds_read_b64_tr_b16 a[2:3], v108 offset:24752
    ds_read_b64_tr_b16 a[4:5], v108 offset:37008
    ds_read_b64_tr_b16 a[6:7], v108 offset:37056
    ds_read_b64_tr_b16 a[8:9], v127 offset:24736
    ds_read_b64_tr_b16 a[10:11], v127 offset:24784
    ds_read_b64_tr_b16 a[12:13], v108 offset:26240
    ds_read_b64_tr_b16 a[14:15], v108 offset:26288
    ds_read_b64_tr_b16 a[16:17], v108 offset:38544
    ds_read_b64_tr_b16 a[18:19], v108 offset:38592
    ds_read_b64_tr_b16 a[20:21], v127 offset:26272
    ds_read_b64_tr_b16 a[22:23], v127 offset:26320
    v_mfma_f32_16x16x32_bf16 v[64:67], a[168:171], v[76:79], v[64:67]
    v_mfma_f32_16x16x32_bf16 v[68:71], a[172:175], v[76:79], v[68:71]
    v_mfma_f32_16x16x32_bf16 v[72:75], a[176:179], v[76:79], v[72:75]
    v_mfma_f32_16x16x32_bf16 v[64:67], a[180:183], v[76:79], v[64:67]
    v_mfma_f32_16x16x32_bf16 v[68:71], a[184:187], v[76:79], v[68:71]
    v_mfma_f32_16x16x32_bf16 v[72:75], a[188:191], v[76:79], v[72:75]
    s_waitcnt lgkmcnt(10)
    v_mfma_f32_16x16x32_bf16 v[64:67], a[0:3], v[76:79], v[64:67]
    s_waitcnt lgkmcnt(8)
    v_mfma_f32_16x16x32_bf16 v[68:71], a[4:7], v[76:79], v[68:71]
    s_waitcnt lgkmcnt(6)
    v_mfma_f32_16x16x32_bf16 v[72:75], a[8:11], v[76:79], v[72:75]
    s_waitcnt lgkmcnt(4)
    v_mfma_f32_16x16x32_bf16 v[64:67], a[12:15], v[76:79], v[64:67]
    s_waitcnt lgkmcnt(2)
    v_mfma_f32_16x16x32_bf16 v[68:71], a[16:19], v[76:79], v[68:71]
    s_waitcnt lgkmcnt(0)
    v_mfma_f32_16x16x32_bf16 v[72:75], a[20:23], v[76:79], v[72:75]
    v_mov_b32 v118, s18
    v_mov_b32 v119, s19
    v_lshlrev_b32 v120, 10, v0
    s_waitcnt vmcnt(3)
    s_barrier
    s_cmp_lg_u32 s68, 0
    s_cbranch_scc1 PB_18
    s_lshl3_add_u32 s92, s70, s15
    s_add_u32 s92, s92, 512
    s_mov_b64 exec, 0xffff
    buffer_store_dwordx2 v[118:119], v120, s[64:67], s92 offen
    s_mov_b64 exec, -1
PB_18:
    s_cmp_lg_u32 s68, 0
    s_cbranch_scc1 PB_19
    v_mov_b32 v120, s74
    v_mov_b32 v121, s75
    s_mov_b64 exec, 1
    s_add_u32 s11, s11, 10240
    buffer_store_dwordx2 v[120:121], v12, s[64:67], s11 offen sc1
    s_mov_b64 exec, -1
PB_19:
    s_add_u32 m0, s8, 144400
    s_nop 0
    buffer_load_dwordx4 v123, s[48:51], s9 offen offset:0 lds
    s_add_u32 m0, s8, 144400
    s_nop 0
    buffer_load_dwordx4 v124, s[48:51], s9 offen offset:1024 lds
    s_add_u32 m0, s8, 144400
    s_nop 0
    buffer_load_dwordx4 v125, s[48:51], s9 offen offset:2048 lds
    s_add_u32 m0, s8, 100352
    s_nop 0
    buffer_load_dwordx4 v123, s[44:47], s5 offen offset:0 lds
    s_add_u32 m0, s8, 100352
    s_nop 0
    buffer_load_dwordx4 v124, s[44:47], s5 offen offset:1024 lds
    s_add_u32 m0, s8, 100352
    s_nop 0
    buffer_load_dwordx4 v125, s[44:47], s5 offen offset:2048 lds
    s_add_u32 m0, s8, 112656
    s_nop 0
    buffer_load_dwordx4 v123, s[48:51], s5 offen offset:0 lds
    s_add_u32 m0, s8, 112656
    s_nop 0
    buffer_load_dwordx4 v124, s[48:51], s5 offen offset:1024 lds
    s_add_u32 m0, s8, 112656
    s_nop 0
    buffer_load_dwordx4 v125, s[48:51], s5 offen offset:2048 lds
    s_lshl_b32 s92, s68, 5
    s_add_u32 s92, s92, 512
    s_mov_b32 m0, s80
    s_add_u32 s93, s92, s15
    s_add_u32 s94, s93, 16384
SP_21:
    s_buffer_load_dwordx8 s[28:35], s[64:67], s93
    s_add_u32 s93, s93, 1024
    s_cmp_gt_u32 s93, s94
    s_cbranch_scc1 SX_23
    s_waitcnt lgkmcnt(0)
    s_xor_b64 s[28:29], s[28:29], s[18:19]
    s_xor_b64 s[30:31], s[30:31], s[18:19]
    s_xor_b64 s[32:33], s[32:33], s[18:19]
    s_xor_b64 s[34:35], s[34:35], s[18:19]
    s_or_b64 s[28:29], s[28:29], s[30:31]
    s_or_b64 s[32:33], s[32:33], s[34:35]
    s_or_b64 s[28:29], s[28:29], s[32:33]
    s_cbranch_scc1 SP_21
SD_20:
    s_barrier
    buffer_load_dwordx4 v12, s[64:67], s76 offen offset:0  lds
    buffer_load_dwordx4 v12, s[64:67], s76 offen offset:1024  lds
    buffer_load_dwordx4 v12, s[64:67], s76 offen offset:2048  lds
    buffer_load_dwordx4 v12, s[64:67], s76 offen offset:3072  lds
    s_add_u32 m0, s80, 8192
    s_add_u32 s76, s76, 65536
    buffer_load_dwordx4 v12, s[64:67], s77 offen offset:0  lds
    buffer_load_dwordx4 v12, s[64:67], s77 offen offset:1024  lds
    buffer_load_dwordx4 v12, s[64:67], s77 offen offset:2048  lds
    buffer_load_dwordx4 v12, s[64:67], s77 offen offset:3072  lds
    s_add_u32 m0, s80, 16384
    s_add_u32 s77, s77, 65536
    s_lshl2_add_u32 s92, s68, 156800
    v_mov_b32 v110, s92
    v_mov_b32 v111, s17
    ds_write_b32 v110, v111
    v_mov_b32 v110, 156800
    v_add_u32 v127, 100352, v127
    v_add_u32 v108, 100352, v108
    s_waitcnt vmcnt(14)
    ds_read_b64_tr_b16 a[24:25], v108 offset:31744
    ds_read_b64_tr_b16 a[26:27], v108 offset:31792
    ds_read_b64_tr_b16 a[28:29], v108 offset:44048
    ds_read_b64_tr_b16 a[30:31], v108 offset:44096
    ds_read_b64_tr_b16 a[32:33], v127 offset:31776
    ds_read_b64_tr_b16 a[34:35], v127 offset:31824
    ds_read_b64_tr_b16 a[36:37], v108 offset:33280
    ds_read_b64_tr_b16 a[38:39], v108 offset:33328
    ds_read_b64_tr_b16 a[40:41], v108 offset:45584
    ds_read_b64_tr_b16 a[42:43], v108 offset:45632
    ds_read_b64_tr_b16 a[44:45], v127 offset:33312
    ds_read_b64_tr_b16 a[46:47], v127 offset:33360
    s_waitcnt vmcnt(8)
    ds_read_b64_tr_b16 a[48:49], v108 offset:0
    ds_read_b64_tr_b16 a[50:51], v108 offset:48
    ds_read_b64_tr_b16 a[52:53], v108 offset:12304
    ds_read_b64_tr_b16 a[54:55], v108 offset:12352
    ds_read_b64_tr_b16 a[56:57], v127 offset:32
    ds_read_b64_tr_b16 a[58:59], v127 offset:80
    ds_read_b64_tr_b16 a[60:61], v108 offset:1536
    ds_read_b64_tr_b16 a[62:63], v108 offset:1584
    ds_read_b64_tr_b16 a[64:65], v108 offset:13840
    ds_read_b64_tr_b16 a[66:67], v108 offset:13888
    ds_read_b64_tr_b16 a[68:69], v127 offset:1568
    ds_read_b64_tr_b16 a[70:71], v127 offset:1616
    s_waitcnt lgkmcnt(15)
    v_mfma_f32_16x16x32_bf16 v[64:67], a[24:27], v[76:79], v[64:67]
    v_mfma_f32_16x16x32_bf16 v[68:71], a[28:31], v[76:79], v[68:71]
    v_mfma_f32_16x16x32_bf16 v[72:75], a[32:35], v[76:79], v[72:75]
    v_mfma_f32_16x16x32_bf16 v[64:67], a[36:39], v[76:79], v[64:67]
    s_waitcnt lgkmcnt(14)
    v_mfma_f32_16x16x32_bf16 v[68:71], a[40:43], v[76:79], v[68:71]
    s_waitcnt lgkmcnt(12)
    v_mfma_f32_16x16x32_bf16 v[72:75], a[44:47], v[76:79], v[72:75]
    s_waitcnt lgkmcnt(10)
    v_mfma_f32_16x16x32_bf16 v[64:67], a[48:51], v[76:79], v[64:67]
    s_waitcnt lgkmcnt(8)
    v_mfma_f32_16x16x32_bf16 v[68:71], a[52:55], v[76:79], v[68:71]
    s_waitcnt lgkmcnt(6)
    v_mfma_f32_16x16x32_bf16 v[72:75], a[56:59], v[76:79], v[72:75]
    s_waitcnt lgkmcnt(4)
    v_mfma_f32_16x16x32_bf16 v[176:179], a[60:63], v[76:79], v[64:67]
    s_waitcnt lgkmcnt(2)
    v_mfma_f32_16x16x32_bf16 v[180:183], a[64:67], v[76:79], v[68:71]
    s_waitcnt lgkmcnt(0)
    v_mfma_f32_16x16x32_bf16 v[184:187], a[68:71], v[76:79], v[72:75]
    s_waitcnt vmcnt(4)
    s_barrier
    ds_read_b128 v[64:67], v6 offset:0
    ds_read_b128 v[68:71], v6 offset:2048
    ds_read_b128 v[72:75], v6 offset:256
    ds_read_b128 v[76:79], v6 offset:2304
    s_waitcnt lgkmcnt(3)
    v_mfma_f32_16x16x32_bf16 v[48:51], a[8:11], v[64:67], 0
    s_waitcnt lgkmcnt(2)
    ds_read_b128 v[80:83], v6 offset:32768
    v_mfma_f32_16x16x32_bf16 v[48:51], a[20:23], v[68:71], v[48:51]
    buffer_load_dwordx4 v[128:131], v12, s[64:67], s81 offen offset:0
    v_mfma_f32_16x16x32_bf16 v[32:35], a[4:7], v[64:67], 0
    v_mfma_f32_16x16x32_bf16 v[32:35], a[16:19], v[68:71], v[32:35]
    ds_read_b128 v[84:87], v6 offset:34816
    v_mfma_f32_16x16x32_bf16 v[16:19], a[0:3], v[64:67], 0
    buffer_load_dwordx4 v[132:135], v12, s[64:67], s81 offen offset:1024
    v_mfma_f32_16x16x32_bf16 v[16:19], a[12:15], v[68:71], v[16:19]
    s_waitcnt lgkmcnt(2)
    v_mfma_f32_16x16x32_bf16 v[20:23], a[0:3], v[72:75], 0
    ds_read_b128 v[88:91], v6 offset:33024
    v_mfma_f32_16x16x32_bf16 v[20:23], a[12:15], v[76:79], v[20:23]
    v_mfma_f32_16x16x32_bf16 v[36:39], a[4:7], v[72:75], 0
    buffer_load_dwordx4 v[136:139], v12, s[64:67], s81 offen offset:2048
    v_mfma_f32_16x16x32_bf16 v[36:39], a[16:19], v[76:79], v[36:39]
    ds_read_b128 v[92:95], v6 offset:35072
    v_mfma_f32_16x16x32_bf16 v[52:55], a[8:11], v[72:75], 0
    v_mfma_f32_16x16x32_bf16 v[52:55], a[20:23], v[76:79], v[52:55]
    s_waitcnt lgkmcnt(2)
    v_mfma_f32_16x16x32_bf16 v[56:59], a[8:11], v[80:83], 0
    ds_read_b128 v[64:67], v6 offset:4096
    v_mfma_f32_16x16x32_bf16 v[56:59], a[20:23], v[84:87], v[56:59]
    buffer_load_dwordx4 v[140:143], v12, s[64:67], s81 offen offset:3072
    v_mfma_f32_16x16x32_bf16 v[40:43], a[4:7], v[80:83], 0
    ds_read_b128 v[122:125], v110
    v_mfma_f32_16x16x32_bf16 v[40:43], a[16:19], v[84:87], v[40:43]
    ds_read_b128 v[68:71], v6 offset:6144
    v_mfma_f32_16x16x32_bf16 v[24:27], a[0:3], v[80:83], 0
    buffer_load_dwordx4 v12, s[64:67], s78 offen offset:0  lds
    v_mfma_f32_16x16x32_bf16 v[24:27], a[12:15], v[84:87], v[24:27]
    s_waitcnt lgkmcnt(3)
    v_mfma_f32_16x16x32_bf16 v[28:31], a[0:3], v[88:91], 0
    ds_read_b128 v[72:75], v6 offset:4352
    v_mfma_f32_16x16x32_bf16 v[28:31], a[12:15], v[92:95], v[28:31]
    s_waitcnt lgkmcnt(2)
    v_or3_b32 v122, v122, v123, v124
    v_or_b32 v122, v122, v125
    v_mfma_f32_16x16x32_bf16 v[44:47], a[4:7], v[88:91], 0
    buffer_load_dwordx4 v12, s[64:67], s78 offen offset:1024  lds
    v_mfma_f32_16x16x32_bf16 v[44:47], a[16:19], v[92:95], v[44:47]
    ds_read_b128 v[76:79], v6 offset:6400
    v_readfirstlane_b32 s17, v122
    v_mfma_f32_16x16x32_bf16 v[60:63], a[8:11], v[88:91], 0
    v_mfma_f32_16x16x32_bf16 v[60:63], a[20:23], v[92:95], v[60:63]
    s_waitcnt lgkmcnt(2)
    v_mfma_f32_16x16x32_bf16 v[48:51], a[32:35], v[64:67], v[48:51]
    ds_read_b128 v[80:83], v6 offset:36864
    v_mfma_f32_16x16x32_bf16 v[48:51], a[44:47], v[68:71], v[48:51]
    buffer_load_dwordx4 v12, s[64:67], s78 offen offset:2048  lds
    v_mfma_f32_16x16x32_bf16 v[32:35], a[28:31], v[64:67], v[32:35]
    v_mfma_f32_16x16x32_bf16 v[32:35], a[40:43], v[68:71], v[32:35]
    ds_read_b128 v[84:87], v6 offset:38912
    v_mfma_f32_16x16x32_bf16 v[16:19], a[24:27], v[64:67], v[16:19]
    buffer_load_dwordx4 v12, s[64:67], s78 offen offset:3072  lds
    v_mfma_f32_16x16x32_bf16 v[16:19], a[36:39], v[68:71], v[16:19]
    s_waitcnt lgkmcnt(2)
    v_mfma_f32_16x16x32_bf16 v[20:23], a[24:27], v[72:75], v[20:23]
    s_add_u32 m0, s80, 24576
    ds_read_b128 v[88:91], v6 offset:37120
    v_and_b32 v111, 8, v0
    v_mfma_f32_16x16x32_bf16 v[20:23], a[36:39], v[76:79], v[20:23]
    s_waitcnt vmcnt(6)
    s_add_u32 s78, s78, 65536
    v_add_f32 v128, v128, v132
    v_mfma_f32_16x16x32_bf16 v[36:39], a[28:31], v[72:75], v[36:39]
    buffer_load_dwordx4 v12, s[64:67], s79 offen offset:0  lds
    v_mfma_f32_16x16x32_bf16 v[36:39], a[40:43], v[76:79], v[36:39]
    ds_read_b128 v[92:95], v6 offset:39168
    v_add_f32 v129, v129, v133
    v_mfma_f32_16x16x32_bf16 v[52:55], a[32:35], v[72:75], v[52:55]
    v_add_f32 v130, v130, v134
    v_add_f32 v131, v131, v135
    v_mfma_f32_16x16x32_bf16 v[52:55], a[44:47], v[76:79], v[52:55]
    s_waitcnt lgkmcnt(2)
    s_barrier
    v_mfma_f32_16x16x32_bf16 v[56:59], a[32:35], v[80:83], v[56:59]
    s_waitcnt vmcnt(6)
    ds_read_b128 v[64:67], v6 offset:8192
    v_add_f32 v128, v128, v136
    v_mfma_f32_16x16x32_bf16 v[56:59], a[44:47], v[84:87], v[56:59]
    buffer_load_dwordx4 v12, s[64:67], s79 offen offset:1024  lds
    v_mfma_f32_16x16x32_bf16 v[40:43], a[28:31], v[80:83], v[40:43]
    v_add_f32 v129, v129, v137
    v_add_f32 v130, v130, v138
    v_mfma_f32_16x16x32_bf16 v[40:43], a[40:43], v[84:87], v[40:43]
    ds_read_b128 v[68:71], v6 offset:10240
    v_add_f32 v131, v131, v139
    v_mfma_f32_16x16x32_bf16 v[24:27], a[24:27], v[80:83], v[24:27]
    buffer_load_dwordx4 v12, s[64:67], s79 offen offset:2048  lds
    v_mfma_f32_16x16x32_bf16 v[24:27], a[36:39], v[84:87], v[24:27]
    s_waitcnt vmcnt(7) lgkmcnt(2)
    v_add_f32 v128, v128, v140
    v_add_f32 v129, v129, v141
    v_mfma_f32_16x16x32_bf16 v[28:31], a[24:27], v[88:91], v[28:31]
    ds_read_b128 v[72:75], v6 offset:8448
    v_add_f32 v130, v130, v142
    v_mfma_f32_16x16x32_bf16 v[28:31], a[36:39], v[92:95], v[28:31]
    v_add_f32 v131, v131, v143
    v_cmp_eq_u32 s[28:29], 0, v111
    v_mfma_f32_16x16x32_bf16 v[44:47], a[28:31], v[88:91], v[44:47]
    buffer_load_dwordx4 v12, s[64:67], s79 offen offset:3072  lds
    v_mfma_f32_16x16x32_bf16 v[44:47], a[40:43], v[92:95], v[44:47]
    s_add_u32 m0, s80, 65536
    ds_read_b128 v[76:79], v6 offset:10496
    v_mfma_f32_16x16x32_bf16 v[60:63], a[32:35], v[88:91], v[60:63]
    s_add_u32 s79, s79, 65536
    v_permlane16_swap_b32 v128, v129
    v_mfma_f32_16x16x32_bf16 v[60:63], a[44:47], v[92:95], v[60:63]
    s_waitcnt lgkmcnt(2)
    v_permlane16_swap_b32 v130, v131
    v_mfma_f32_16x16x32_bf16 v[48:51], a[56:59], v[64:67], v[48:51]
    ds_read_b128 v[80:83], v6 offset:40960
    v_add_f32 v128, v128, v129
    v_mfma_f32_16x16x32_bf16 v[48:51], a[68:71], v[68:71], v[48:51]
    buffer_load_dwordx4 v12, s[64:67], s76 offen offset:0  lds
    v_mfma_f32_16x16x32_bf16 v[32:35], a[52:55], v[64:67], v[32:35]
    v_add_f32 v130, v130, v131
    v_mfma_f32_16x16x32_bf16 v[32:35], a[64:67], v[68:71], v[32:35]
    ds_read_b128 v[84:87], v6 offset:43008
    v_mfma_f32_16x16x32_bf16 v[16:19], a[48:51], v[64:67], v[16:19]
    buffer_load_dwordx2 v[120:121], v115, s[64:67], s85 offen offset:0 sc1
    v_mfma_f32_16x16x32_bf16 v[16:19], a[60:63], v[68:71], v[16:19]
    s_waitcnt lgkmcnt(2)
    v_permlane32_swap_b32 v128, v130
    v_mfma_f32_16x16x32_bf16 v[20:23], a[48:51], v[72:75], v[20:23]
    ds_read_b128 v[88:91], v6 offset:41216
    v_add_f32 v128, v128, v130
    v_mfma_f32_16x16x32_bf16 v[20:23], a[60:63], v[76:79], v[20:23]
    buffer_load_dwordx4 v12, s[64:67], s76 offen offset:1024  lds
    v_mfma_f32_16x16x32_bf16 v[36:39], a[52:55], v[72:75], v[36:39]
    buffer_load_dwordx4 v12, s[64:67], s76 offen offset:2048  lds
    v_mfma_f32_16x16x32_bf16 v[36:39], a[64:67], v[76:79], v[36:39]
    ds_read_b128 v[92:95], v6 offset:43264
    v_mov_b32_dpp v129, v128 row_ror:8 row_mask:0xf bank_mask:0xf
    v_mfma_f32_16x16x32_bf16 v[52:55], a[56:59], v[72:75], v[52:55]
    v_cndmask_b32 v130, v129, v128, s[28:29]
    v_cndmask_b32 v131, v128, v129, s[28:29]
    v_mfma_f32_16x16x32_bf16 v[52:55], a[68:71], v[76:79], v[52:55]
    s_waitcnt lgkmcnt(2)
    v_mul_f32 v130, 0.001953125, v130
    v_mul_f32 v131, 0.001953125, v131
    v_mfma_f32_16x16x32_bf16 v[56:59], a[56:59], v[80:83], v[56:59]
    ds_read_b128 v[64:67], v6 offset:12288
    v_fma_f32 v131, -v130, v130, v131
    v_mfma_f32_16x16x32_bf16 v[56:59], a[68:71], v[84:87], v[56:59]
    buffer_load_dwordx4 v12, s[64:67], s76 offen offset:3072  lds
    v_mfma_f32_16x16x32_bf16 v[40:43], a[52:55], v[80:83], v[40:43]
    s_add_u32 m0, s80, 73728
    v_cvt_pk_bf16_f32 v132, -v130, -v130
    v_max_f32 v131, 0, v131
    v_mfma_f32_16x16x32_bf16 v[40:43], a[64:67], v[84:87], v[40:43]
    ds_read_b128 v[68:71], v6 offset:14336
    v_cvt_pk_bf16_f32 v131, v131, v131
    v_mfma_f32_16x16x32_bf16 v[24:27], a[48:51], v[80:83], v[24:27]
    buffer_load_dwordx4 v12, s[64:67], s77 offen offset:0  lds
    v_mfma_f32_16x16x32_bf16 v[24:27], a[60:63], v[84:87], v[24:27]
    s_waitcnt lgkmcnt(2)
    v_and_b32 v131, 0xffff0000, v131
    v_add_f32 v131, 0x3727c5ac, v131
    v_mfma_f32_16x16x32_bf16 v[28:31], a[48:51], v[88:91], v[28:31]
    ds_read_b128 v[72:75], v6 offset:12544
    v_cvt_pk_bf16_f32 v131, v131, v131
    v_mfma_f32_16x16x32_bf16 v[28:31], a[60:63], v[92:95], v[28:31]
    v_and_b32 v131, 0xffff0000, v131
    v_mfma_f32_16x16x32_bf16 v[44:47], a[52:55], v[88:91], v[44:47]
    buffer_load_dwordx4 v12, s[64:67], s77 offen offset:1024  lds
    v_mfma_f32_16x16x32_bf16 v[44:47], a[64:67], v[92:95], v[44:47]
    ds_read_b128 v[76:79], v6 offset:14592
    v_mfma_f32_16x16x32_bf16 v[60:63], a[56:59], v[88:91], v[60:63]
    v_sqrt_f32 v131, v131
    v_mfma_f32_16x16x32_bf16 v[60:63], a[68:71], v[92:95], v[60:63]
    s_waitcnt lgkmcnt(2)
    v_cvt_pk_bf16_f32 v131, v131, v131
    v_and_b32 v131, 0xffff0000, v131
    v_mfma_f32_16x16x32_bf16 v[48:51], a[80:83], v[64:67], v[48:51]
    ds_read_b128 v[80:83], v6 offset:45056
    v_mfma_f32_16x16x32_bf16 v[48:51], a[92:95], v[68:71], v[48:51]
    buffer_load_dwordx4 v12, s[64:67], s77 offen offset:2048  lds
    v_mfma_f32_16x16x32_bf16 v[32:35], a[76:79], v[64:67], v[32:35]
    v_rcp_f32 v136, v131
    v_mfma_f32_16x16x32_bf16 v[32:35], a[88:91], v[68:71], v[32:35]
    ds_read_b128 v[84:87], v6 offset:47104
    v_and_b32 v132, 0xffff0000, v132
    v_mfma_f32_16x16x32_bf16 v[16:19], a[72:75], v[64:67], v[16:19]
    buffer_load_dwordx4 v12, s[64:67], s77 offen offset:3072  lds
    v_mfma_f32_16x16x32_bf16 v[16:19], a[84:87], v[68:71], v[16:19]
    s_waitcnt lgkmcnt(2)
    v_mul_f32 v136, v136, v136
    v_mfma_f32_16x16x32_bf16 v[20:23], a[72:75], v[72:75], v[20:23]
    s_add_u32 m0, s80, 81920
    ds_read_b128 v[88:91], v6 offset:45312
    v_mfma_f32_16x16x32_bf16 v[20:23], a[84:87], v[76:79], v[20:23]
    ds_write2st64_b32 v10, v132, v136 offset1:2
    v_mfma_f32_16x16x32_bf16 v[36:39], a[76:79], v[72:75], v[36:39]
    buffer_load_dwordx4 v12, s[64:67], s78 offen offset:0  lds
    v_mfma_f32_16x16x32_bf16 v[36:39], a[88:91], v[76:79], v[36:39]
    ds_read_b128 v[92:95], v6 offset:47360
    v_mfma_f32_16x16x32_bf16 v[52:55], a[80:83], v[72:75], v[52:55]
    v_mfma_f32_16x16x32_bf16 v[52:55], a[92:95], v[76:79], v[52:55]
    s_waitcnt vmcnt(14) lgkmcnt(1)
    s_barrier
    v_mfma_f32_16x16x32_bf16 v[56:59], a[80:83], v[80:83], v[56:59]
    ds_read_b128 v[64:67], v6 offset:16384
    ds_read2_b32 v[188:189], v9 offset1:16
    v_mfma_f32_16x16x32_bf16 v[56:59], a[92:95], v[84:87], v[56:59]
    buffer_load_dwordx4 v12, s[64:67], s78 offen offset:1024  lds
    v_mfma_f32_16x16x32_bf16 v[40:43], a[76:79], v[80:83], v[40:43]
    ds_read2_b32 v[190:191], v9 offset0:32 offset1:48
    ds_read2_b32 v[116:117], v9 offset0:64 offset1:96
    v_mfma_f32_16x16x32_bf16 v[40:43], a[88:91], v[84:87], v[40:43]
    ds_read_b128 v[68:71], v6 offset:18432
    ds_read2_b32 v[118:119], v9 offset0:80 offset1:112
    v_mfma_f32_16x16x32_bf16 v[24:27], a[72:75], v[80:83], v[24:27]
    v_mfma_f32_16x16x32_bf16 v[24:27], a[84:87], v[84:87], v[24:27]
    s_waitcnt lgkmcnt(6)
    v_mfma_f32_16x16x32_bf16 v[28:31], a[72:75], v[88:91], v[28:31]
    ds_read_b128 v[72:75], v6 offset:16640
    v_mfma_f32_16x16x32_bf16 v[28:31], a[84:87], v[92:95], v[28:31]
    buffer_load_dwordx4 v12, s[64:67], s78 offen offset:2048  lds
    v_mfma_f32_16x16x32_bf16 v[44:47], a[76:79], v[88:91], v[44:47]
    s_waitcnt vmcnt(10)
    v_cmp_ne_u64 vcc, s[74:75], v[120:121]
    v_mfma_f32_16x16x32_bf16 v[44:47], a[88:91], v[92:95], v[44:47]
    ds_read_b128 v[76:79], v6 offset:18688
    v_mfma_f32_16x16x32_bf16 v[60:63], a[80:83], v[88:91], v[60:63]
    v_mfma_f32_16x16x32_bf16 v[60:63], a[92:95], v[92:95], v[60:63]
    s_waitcnt lgkmcnt(3)
    v_fmac_f32 v19, v188, v179
    v_fmac_f32 v35, v188, v183
    v_mfma_f32_16x16x32_bf16 v[48:51], a[104:107], v[64:67], v[48:51]
    s_cbranch_vccnz PS_32
PR_33:
    ds_read_b128 v[80:83], v6 offset:49152
    v_fmac_f32 v23, v189, v179
    v_mfma_f32_16x16x32_bf16 v[48:51], a[116:119], v[68:71], v[48:51]
    v_fmac_f32 v39, v189, v183
    v_fmac_f32 v55, v189, v187
    v_mfma_f32_16x16x32_bf16 v[32:35], a[100:103], v[64:67], v[32:35]
    v_fmac_f32 v27, v190, v179
    v_fmac_f32 v43, v190, v183
    v_mfma_f32_16x16x32_bf16 v[32:35], a[112:115], v[68:71], v[32:35]
    ds_read_b128 v[84:87], v6 offset:51200
    v_fmac_f32 v59, v190, v187
    v_mfma_f32_16x16x32_bf16 v[16:19], a[96:99], v[64:67], v[16:19]
    buffer_load_dwordx4 v12, s[64:67], s78 offen offset:3072  lds
    v_mfma_f32_16x16x32_bf16 v[16:19], a[108:111], v[68:71], v[16:19]
    s_waitcnt lgkmcnt(2)
    v_fmac_f32 v31, v191, v179
    v_fmac_f32 v47, v191, v183
    v_mfma_f32_16x16x32_bf16 v[20:23], a[96:99], v[72:75], v[20:23]
    s_add_u32 m0, s80, 90112
    ds_read_b128 v[88:91], v6 offset:49408
    v_fmac_f32 v51, v188, v187
    v_mfma_f32_16x16x32_bf16 v[20:23], a[108:111], v[76:79], v[20:23]
    v_fmac_f32 v63, v191, v187
    v_fmac_f32 v50, v188, v186
    v_mfma_f32_16x16x32_bf16 v[36:39], a[100:103], v[72:75], v[36:39]
    v_fmac_f32 v34, v188, v182
    v_fmac_f32 v26, v190, v178
    v_mfma_f32_16x16x32_bf16 v[36:39], a[112:115], v[76:79], v[36:39]
    ds_read_b128 v[92:95], v6 offset:51456
    v_fmac_f32 v42, v190, v182
    v_mfma_f32_16x16x32_bf16 v[52:55], a[104:107], v[72:75], v[52:55]
    v_fmac_f32 v18, v188, v178
    v_fmac_f32 v30, v191, v178
    v_mfma_f32_16x16x32_bf16 v[52:55], a[116:119], v[76:79], v[52:55]
    s_waitcnt lgkmcnt(2)
    v_fmac_f32 v46, v191, v182
    v_fmac_f32 v62, v191, v186
    v_mfma_f32_16x16x32_bf16 v[56:59], a[104:107], v[80:83], v[56:59]
    ds_read_b128 v[64:67], v6 offset:20480
    v_fmac_f32 v22, v189, v178
    v_mfma_f32_16x16x32_bf16 v[56:59], a[116:119], v[84:87], v[56:59]
    buffer_load_dwordx4 v12, s[64:67], s79 offen offset:0  lds
    v_mfma_f32_16x16x32_bf16 v[40:43], a[100:103], v[80:83], v[40:43]
    v_fmac_f32 v38, v189, v182
    v_fmac_f32 v17, v188, v177
    v_mfma_f32_16x16x32_bf16 v[40:43], a[112:115], v[84:87], v[40:43]
    ds_read_b128 v[68:71], v6 offset:22528
    v_fmac_f32 v33, v188, v181
    v_mfma_f32_16x16x32_bf16 v[24:27], a[96:99], v[80:83], v[24:27]
    buffer_load_dwordx4 v12, s[64:67], s79 offen offset:1024  lds
    v_mfma_f32_16x16x32_bf16 v[24:27], a[108:111], v[84:87], v[24:27]
    s_waitcnt lgkmcnt(2)
    v_fmac_f32 v54, v189, v186
    v_fmac_f32 v49, v188, v185
    v_mfma_f32_16x16x32_bf16 v[28:31], a[96:99], v[88:91], v[28:31]
    ds_read_b128 v[72:75], v6 offset:20736
    v_fmac_f32 v58, v190, v186
    v_mfma_f32_16x16x32_bf16 v[28:31], a[108:111], v[92:95], v[28:31]
    v_fmac_f32 v21, v189, v177
    v_fmac_f32 v37, v189, v181
    v_mfma_f32_16x16x32_bf16 v[44:47], a[100:103], v[88:91], v[44:47]
    buffer_load_dwordx4 a[192:195], v13, s[64:67], s12 offen
    v_mfma_f32_16x16x32_bf16 v[44:47], a[112:115], v[92:95], v[44:47]
    ds_read_b128 v[76:79], v6 offset:22784
    v_fmac_f32 v53, v189, v185
    v_mfma_f32_16x16x32_bf16 v[60:63], a[104:107], v[88:91], v[60:63]
    v_fmac_f32 v25, v190, v177
    v_fmac_f32 v41, v190, v181
    v_mfma_f32_16x16x32_bf16 v[60:63], a[116:119], v[92:95], v[60:63]
    s_waitcnt lgkmcnt(2)
    v_fmac_f32 v57, v190, v185
    v_fmac_f32 v16, v188, v176
    v_mfma_f32_16x16x32_bf16 v[48:51], a[128:131], v[64:67], v[48:51]
    ds_read_b128 v[80:83], v6 offset:53248
HOP_5:
    s_cbranch_execz HR_11
    v_fmac_f32 v29, v191, v177
    v_mfma_f32_16x16x32_bf16 v[48:51], a[140:143], v[68:71], v[48:51]
    buffer_load_dwordx4 v12, s[64:67], s79 offen offset:2048  lds
    v_mfma_f32_16x16x32_bf16 v[32:35], a[124:127], v[64:67], v[32:35]
    v_fmac_f32 v45, v191, v181
    v_fmac_f32 v20, v189, v176
    v_mfma_f32_16x16x32_bf16 v[32:35], a[136:139], v[68:71], v[32:35]
    ds_read_b128 v[84:87], v6 offset:55296
    v_fmac_f32 v36, v189, v180
    v_mfma_f32_16x16x32_bf16 v[16:19], a[120:123], v[64:67], v[16:19]
    buffer_load_dwordx4 a[196:199], v14, s[64:67], s12 offen
    v_mfma_f32_16x16x32_bf16 v[16:19], a[132:135], v[68:71], v[16:19]
    s_waitcnt lgkmcnt(2)
    v_fmac_f32 v61, v191, v185
    v_fmac_f32 v52, v189, v184
    v_mfma_f32_16x16x32_bf16 v[20:23], a[120:123], v[72:75], v[20:23]
    ds_read_b128 v[88:91], v6 offset:53504
    v_fmac_f32 v48, v188, v184
    v_mfma_f32_16x16x32_bf16 v[20:23], a[132:135], v[76:79], v[20:23]
    buffer_load_dwordx4 v12, s[64:67], s79 offen offset:3072  lds
    v_mfma_f32_16x16x32_bf16 v[36:39], a[124:127], v[72:75], v[36:39]
    v_fmac_f32 v32, v188, v180
    v_fmac_f32 v24, v190, v176
    v_mfma_f32_16x16x32_bf16 v[36:39], a[136:139], v[76:79], v[36:39]
    ds_read_b128 v[92:95], v6 offset:55552
    v_fmac_f32 v40, v190, v180
    v_mfma_f32_16x16x32_bf16 v[52:55], a[128:131], v[72:75], v[52:55]
    buffer_load_dwordx4 a[200:203], v112, s[64:67], s12 offen
    v_mfma_f32_16x16x32_bf16 v[52:55], a[140:143], v[76:79], v[52:55]
    s_waitcnt lgkmcnt(2)
    s_barrier
    v_mfma_f32_16x16x32_bf16 v[56:59], a[128:131], v[80:83], v[56:59]
    ds_read_b128 v[64:67], v6 offset:24576
    v_fmac_f32 v28, v191, v176
    v_mfma_f32_16x16x32_bf16 v[56:59], a[140:143], v[84:87], v[56:59]
    buffer_load_dwordx4 a[204:207], v113, s[64:67], s12 offen
    v_mfma_f32_16x16x32_bf16 v[40:43], a[124:127], v[80:83], v[40:43]
    s_add_u32 s12, s12, 4096
    v_fmac_f32 v44, v191, v180
    v_fmac_f32 v60, v191, v184
    v_mfma_f32_16x16x32_bf16 v[40:43], a[136:139], v[84:87], v[40:43]
    ds_read_b128 v[68:71], v6 offset:26624
    v_mfma_f32_16x16x32_bf16 v[24:27], a[120:123], v[80:83], v[24:27]
    v_mfma_f32_16x16x32_bf16 v[24:27], a[132:135], v[84:87], v[24:27]
    s_waitcnt lgkmcnt(2)
    v_mfma_f32_16x16x32_bf16 v[28:31], a[120:123], v[88:91], v[28:31]
    ds_read_b128 v[72:75], v6 offset:57344
    v_fmac_f32 v56, v190, v184
    v_mfma_f32_16x16x32_bf16 v[28:31], a[132:135], v[92:95], v[28:31]
    buffer_load_dwordx4 a[208:211], v13, s[64:67], s12 offen
    v_mfma_f32_16x16x32_bf16 v[44:47], a[124:127], v[88:91], v[44:47]
    v_mul_f32 v128, v116, v176
    v_mul_f32 v129, v116, v177
    v_mfma_f32_16x16x32_bf16 v[44:47], a[136:139], v[92:95], v[44:47]
    ds_read_b128 v[76:79], v6 offset:59392
    v_mul_f32 v130, v116, v178
    v_mfma_f32_16x16x32_bf16 v[60:63], a[128:131], v[88:91], v[60:63]
    v_mul_f32 v131, v116, v179
    v_mul_f32 v144, v116, v180
    v_mfma_f32_16x16x32_bf16 v[60:63], a[140:143], v[92:95], v[60:63]
    s_waitcnt lgkmcnt(2)
    v_mul_f32 v145, v116, v181
    v_mul_f32 v146, v116, v182
    v_mfma_f32_16x16x32_bf16 v[48:51], a[152:155], v[64:67], v[48:51]
    ds_read_b128 v[80:83], v6 offset:28672
    v_mul_f32 v147, v116, v183
    v_mfma_f32_16x16x32_bf16 v[48:51], a[164:167], v[68:71], v[48:51]
    buffer_load_dwordx4 a[212:215], v14, s[64:67], s12 offen
    v_mfma_f32_16x16x32_bf16 v[32:35], a[148:151], v[64:67], v[32:35]
    v_mul_f32 v160, v116, v184
    v_mul_f32 v161, v116, v185
    v_mfma_f32_16x16x32_bf16 v[32:35], a[160:163], v[68:71], v[32:35]
    ds_read_b128 v[84:87], v6 offset:30720
    v_mul_f32 v162, v116, v186
    v_mfma_f32_16x16x32_bf16 v[16:19], a[144:147], v[64:67], v[16:19]
    v_mul_f32 v163, v116, v187
    v_mul_f32 v136, v117, v176
    v_mfma_f32_16x16x32_bf16 v[16:19], a[156:159], v[68:71], v[16:19]
    s_waitcnt lgkmcnt(2)
    v_mul_f32 v137, v117, v177
    v_mul_f32 v138, v117, v178
    v_mfma_f32_16x16x32_bf16 v[24:27], a[144:147], v[72:75], v[24:27]
    ds_read_b128 v[88:91], v6 offset:61440
    v_mul_f32 v139, v117, v179
    v_mfma_f32_16x16x32_bf16 v[24:27], a[156:159], v[76:79], v[24:27]
    buffer_load_dwordx4 a[216:219], v112, s[64:67], s12 offen
    v_mfma_f32_16x16x32_bf16 v[40:43], a[148:151], v[72:75], v[40:43]
    v_mul_f32 v152, v117, v180
    v_mul_f32 v153, v117, v181
    v_mfma_f32_16x16x32_bf16 v[40:43], a[160:163], v[76:79], v[40:43]
    ds_read_b128 v[92:95], v6 offset:63488
    v_mul_f32 v154, v117, v182
    v_mfma_f32_16x16x32_bf16 v[56:59], a[152:155], v[72:75], v[56:59]
    v_mul_f32 v155, v117, v183
    v_mul_f32 v168, v117, v184
    v_mfma_f32_16x16x32_bf16 v[56:59], a[164:167], v[76:79], v[56:59]
    s_waitcnt lgkmcnt(2)
    v_mul_f32 v169, v117, v185
    v_mul_f32 v170, v117, v186
    v_mfma_f32_16x16x32_bf16 v[48:51], a[176:179], v[80:83], v[48:51]
    ds_read_b128 v[64:67], v6 offset:24832
    v_mul_f32 v171, v117, v187
    v_mfma_f32_16x16x32_bf16 v[48:51], a[188:191], v[84:87], v[48:51]
    buffer_load_dwordx4 a[220:223], v113, s[64:67], s12 offen
    v_mfma_f32_16x16x32_bf16 v[32:35], a[172:175], v[80:83], v[32:35]
    s_lshl1_add_u32 s12, s53, s26
    v_mfma_f32_16x16x32_bf16 v[32:35], a[184:187], v[84:87], v[32:35]
    ds_read_b128 v[68:71], v6 offset:26880
    v_mfma_f32_16x16x32_bf16 v[16:19], a[168:171], v[80:83], v[16:19]
    v_mfma_f32_16x16x32_bf16 v[16:19], a[180:183], v[84:87], v[16:19]
    s_waitcnt lgkmcnt(2)
    v_mfma_f32_16x16x32_bf16 v[24:27], a[168:171], v[88:91], v[24:27]
    ds_read_b128 v[72:75], v6 offset:57600
    v_mfma_f32_16x16x32_bf16 v[24:27], a[180:183], v[92:95], v[24:27]
    buffer_load_dwordx4 a[224:227], v13, s[64:67], s12 offen
    v_mfma_f32_16x16x32_bf16 v[40:43], a[172:175], v[88:91], v[40:43]
    v_mfma_f32_16x16x32_bf16 v[40:43], a[184:187], v[92:95], v[40:43]
    ds_read_b128 v[76:79], v6 offset:59648
    v_mfma_f32_16x16x32_bf16 v[56:59], a[176:179], v[88:91], v[56:59]
    v_mfma_f32_16x16x32_bf16 v[56:59], a[188:191], v[92:95], v[56:59]
    s_waitcnt lgkmcnt(2)
    v_mfma_f32_16x16x32_bf16 v[52:55], a[152:155], v[64:67], v[52:55]
    ds_read_b128 v[80:83], v6 offset:28928
    v_mfma_f32_16x16x32_bf16 v[52:55], a[164:167], v[68:71], v[52:55]
    buffer_load_dwordx4 a[228:231], v14, s[64:67], s12 offen
    v_mfma_f32_16x16x32_bf16 v[36:39], a[148:151], v[64:67], v[36:39]
    v_mul_f32 v32, v16, v32
    v_mul_f32 v33, v17, v33
    v_mfma_f32_16x16x32_bf16 v[36:39], a[160:163], v[68:71], v[36:39]
    ds_read_b128 v[84:87], v6 offset:30976
    v_mul_f32 v34, v18, v34
    v_mfma_f32_16x16x32_bf16 v[20:23], a[144:147], v[64:67], v[20:23]
    v_permlane16_swap_b32 v48, v50
    v_mfma_f32_16x16x32_bf16 v[20:23], a[156:159], v[68:71], v[20:23]
    s_waitcnt lgkmcnt(2)
    v_permlane16_swap_b32 v49, v51
    v_mfma_f32_16x16x32_bf16 v[28:31], a[144:147], v[72:75], v[28:31]
    ds_read_b128 v[88:91], v6 offset:61696
    v_mul_f32 v35, v19, v35
    v_mfma_f32_16x16x32_bf16 v[28:31], a[156:159], v[76:79], v[28:31]
    buffer_load_dwordx4 a[232:235], v112, s[64:67], s12 offen
    v_mfma_f32_16x16x32_bf16 v[44:47], a[148:151], v[72:75], v[44:47]
    v_permlane16_swap_b32 v56, v58
    v_mfma_f32_16x16x32_bf16 v[44:47], a[160:163], v[76:79], v[44:47]
    ds_read_b128 v[92:95], v6 offset:63744
    v_mul_f32 v40, v24, v40
    v_mfma_f32_16x16x32_bf16 v[60:63], a[152:155], v[72:75], v[60:63]
    v_permlane16_swap_b32 v57, v59
    v_mfma_f32_16x16x32_bf16 v[60:63], a[164:167], v[76:79], v[60:63]
    s_waitcnt vmcnt(9) lgkmcnt(2)
    s_barrier
    v_mfma_f32_16x16x32_bf16 v[52:55], a[176:179], v[80:83], v[52:55]
    ds_read_b128 v[64:67], v7 offset:0
    v_mul_f32 v41, v25, v41
    v_mfma_f32_16x16x32_bf16 v[52:55], a[188:191], v[84:87], v[52:55]
    buffer_load_dwordx4 a[236:239], v113, s[64:67], s12 offen
    v_mfma_f32_16x16x32_bf16 v[36:39], a[172:175], v[80:83], v[36:39]
    s_add_u32 s12, s12, 4096
    v_mul_f32 v42, v26, v42
    v_mul_f32 v43, v27, v43
    v_mfma_f32_16x16x32_bf16 v[36:39], a[184:187], v[84:87], v[36:39]
    ds_read_b128 v[68:71], v7 offset:2048
    v_cvt_pk_bf16_f32 v16, v32, v33
    v_mfma_f32_16x16x32_bf16 v[20:23], a[168:171], v[80:83], v[20:23]
    v_cvt_pk_bf16_f32 v17, v34, v35
    v_cvt_pk_bf16_f32 v18, v40, v41
    v_mfma_f32_16x16x32_bf16 v[20:23], a[180:183], v[84:87], v[20:23]
    s_waitcnt lgkmcnt(2)
    v_cvt_pk_bf16_f32 v19, v42, v43
    v_mul_f32 v48, v48, v50
    v_mfma_f32_16x16x32_bf16 v[28:31], a[168:171], v[88:91], v[28:31]
    ds_read_b128 v[72:75], v7 offset:32768
    v_mul_f32 v49, v49, v51
    v_mfma_f32_16x16x32_bf16 v[28:31], a[180:183], v[92:95], v[28:31]
    buffer_load_dwordx4 a[240:243], v13, s[64:67], s12 offen
    v_mfma_f32_16x16x32_bf16 v[44:47], a[172:175], v[88:91], v[44:47]
    v_mul_f32 v56, v56, v58
    v_mul_f32 v57, v57, v59
    v_mfma_f32_16x16x32_bf16 v[44:47], a[184:187], v[92:95], v[44:47]
    ds_read_b128 v[76:79], v7 offset:34816
    v_cvt_pk_bf16_f32 v24, v48, v49
    v_mfma_f32_16x16x32_bf16 v[60:63], a[176:179], v[88:91], v[60:63]
    v_cvt_pk_bf16_f32 v25, v56, v57
    v_mfma_f32_16x16x32_bf16 v[60:63], a[188:191], v[92:95], v[60:63]
    s_waitcnt lgkmcnt(2)
    v_permlane16_swap_b32 v16, v18
    v_mfma_f32_16x16x32_bf16 v[160:163], a[8:11], v[64:67], v[160:163]
    ds_read_b128 v[80:83], v7 offset:4096
    v_mfma_f32_16x16x32_bf16 v[160:163], a[20:23], v[68:71], v[160:163]
    buffer_load_dwordx4 a[244:247], v14, s[64:67], s12 offen
    v_mfma_f32_16x16x32_bf16 v[144:147], a[4:7], v[64:67], v[144:147]
    v_permlane16_swap_b32 v17, v19
    v_mfma_f32_16x16x32_bf16 v[144:147], a[16:19], v[68:71], v[144:147]
    ds_read_b128 v[84:87], v7 offset:6144
    v_mul_f32 v36, v20, v36
    v_mfma_f32_16x16x32_bf16 v[128:131], a[0:3], v[64:67], v[128:131]
    buffer_store_dwordx4 v[16:19], v104, s[64:67], s82 offen offset:0 sc1
    v_mfma_f32_16x16x32_bf16 v[128:131], a[12:15], v[68:71], v[128:131]
    s_waitcnt lgkmcnt(2)
    v_permlane16_swap_b32 v24, v25
    v_mfma_f32_16x16x32_bf16 v[136:139], a[0:3], v[72:75], v[136:139]
    ds_read_b128 v[88:91], v7 offset:36864
    v_mul_f32 v37, v21, v37
    v_mfma_f32_16x16x32_bf16 v[136:139], a[12:15], v[76:79], v[136:139]
    buffer_load_dwordx4 a[248:251], v112, s[64:67], s12 offen
    v_mfma_f32_16x16x32_bf16 v[152:155], a[4:7], v[72:75], v[152:155]
    buffer_store_dwordx2 v[24:25], v105, s[64:67], s82 offen offset:1024 sc1
    v_mfma_f32_16x16x32_bf16 v[152:155], a[16:19], v[76:79], v[152:155]
    ds_read_b128 v[92:95], v7 offset:38912
    v_mul_f32 v38, v22, v38
    v_mfma_f32_16x16x32_bf16 v[168:171], a[8:11], v[72:75], v[168:171]
    v_permlane16_swap_b32 v52, v54
    v_mfma_f32_16x16x32_bf16 v[168:171], a[20:23], v[76:79], v[168:171]
    s_waitcnt lgkmcnt(2)
    v_permlane16_swap_b32 v53, v55
    v_mfma_f32_16x16x32_bf16 v[160:163], a[32:35], v[80:83], v[160:163]
    ds_read_b128 v[64:67], v7 offset:8192
    v_mul_f32 v39, v23, v39
    v_mfma_f32_16x16x32_bf16 v[160:163], a[44:47], v[84:87], v[160:163]
    buffer_load_dwordx4 a[252:255], v113, s[64:67], s12 offen
    v_mfma_f32_16x16x32_bf16 v[144:147], a[28:31], v[80:83], v[144:147]
    s_lshl1_add_u32 s12, s54, s26
    v_permlane16_swap_b32 v60, v62
    v_mfma_f32_16x16x32_bf16 v[144:147], a[40:43], v[84:87], v[144:147]
    ds_read_b128 v[68:71], v7 offset:10240
    v_mul_f32 v44, v28, v44
    v_mfma_f32_16x16x32_bf16 v[128:131], a[24:27], v[80:83], v[128:131]
    v_permlane16_swap_b32 v61, v63
    v_mfma_f32_16x16x32_bf16 v[128:131], a[36:39], v[84:87], v[128:131]
    s_waitcnt lgkmcnt(2)
    v_mul_f32 v45, v29, v45
    v_mul_f32 v46, v30, v46
    v_mfma_f32_16x16x32_bf16 v[136:139], a[24:27], v[88:91], v[136:139]
    ds_read_b128 v[72:75], v7 offset:40960
    v_mul_f32 v47, v31, v47
    v_mfma_f32_16x16x32_bf16 v[136:139], a[36:39], v[92:95], v[136:139]
    buffer_load_dwordx4 v[192:195], v13, s[64:67], s12 offen
    v_mfma_f32_16x16x32_bf16 v[152:155], a[28:31], v[88:91], v[152:155]
    v_cvt_pk_bf16_f32 v20, v36, v37
    v_cvt_pk_bf16_f32 v21, v38, v39
    v_mfma_f32_16x16x32_bf16 v[152:155], a[40:43], v[92:95], v[152:155]
    ds_read_b128 v[76:79], v7 offset:43008
    v_cvt_pk_bf16_f32 v22, v44, v45
    v_mfma_f32_16x16x32_bf16 v[168:171], a[32:35], v[88:91], v[168:171]
    v_cvt_pk_bf16_f32 v23, v46, v47
    v_mul_f32 v52, v52, v54
    v_mfma_f32_16x16x32_bf16 v[168:171], a[44:47], v[92:95], v[168:171]
    s_waitcnt lgkmcnt(2)
    v_mul_f32 v53, v53, v55
    v_mul_f32 v60, v60, v62
    v_mfma_f32_16x16x32_bf16 v[160:163], a[56:59], v[64:67], v[160:163]
    ds_read_b128 v[80:83], v7 offset:12288
    v_mul_f32 v61, v61, v63
    v_mfma_f32_16x16x32_bf16 v[160:163], a[68:71], v[68:71], v[160:163]
    buffer_load_dwordx4 v[196:199], v14, s[64:67], s12 offen
    v_mfma_f32_16x16x32_bf16 v[144:147], a[52:55], v[64:67], v[144:147]
    v_cvt_pk_bf16_f32 v28, v52, v53
    v_cvt_pk_bf16_f32 v29, v60, v61
    v_mfma_f32_16x16x32_bf16 v[144:147], a[64:67], v[68:71], v[144:147]
    ds_read_b128 v[84:87], v7 offset:14336
    v_mfma_f32_16x16x32_bf16 v[128:131], a[48:51], v[64:67], v[128:131]
    v_permlane16_swap_b32 v20, v22
    v_mfma_f32_16x16x32_bf16 v[128:131], a[60:63], v[68:71], v[128:131]
    s_waitcnt lgkmcnt(2)
    v_permlane16_swap_b32 v21, v23
    v_mfma_f32_16x16x32_bf16 v[136:139], a[48:51], v[72:75], v[136:139]
    ds_read_b128 v[88:91], v7 offset:45056
    v_mfma_f32_16x16x32_bf16 v[136:139], a[60:63], v[76:79], v[136:139]
    buffer_load_dwordx4 v[200:203], v112, s[64:67], s12 offen
    v_mfma_f32_16x16x32_bf16 v[152:155], a[52:55], v[72:75], v[152:155]
    buffer_store_dwordx4 v[20:23], v104, s[64:67], s82 offen offset:256 sc1
    v_mfma_f32_16x16x32_bf16 v[152:155], a[64:67], v[76:79], v[152:155]
    ds_read_b128 v[92:95], v7 offset:47104
    v_mfma_f32_16x16x32_bf16 v[168:171], a[56:59], v[72:75], v[168:171]
    v_permlane16_swap_b32 v28, v29
    v_mfma_f32_16x16x32_bf16 v[168:171], a[68:71], v[76:79], v[168:171]
    s_waitcnt lgkmcnt(2)
    buffer_store_dwordx2 v[28:29], v105, s[64:67], s82 offen offset:1280 sc1
    v_mfma_f32_16x16x32_bf16 v[160:163], a[80:83], v[80:83], v[160:163]
    ds_read_b128 v[64:67], v7 offset:16384
    v_mul_f32 v132, v118, v176
    v_mfma_f32_16x16x32_bf16 v[160:163], a[92:95], v[84:87], v[160:163]
    buffer_load_dwordx4 v[204:207], v113, s[64:67], s12 offen
    v_mfma_f32_16x16x32_bf16 v[144:147], a[76:79], v[80:83], v[144:147]
    s_add_u32 s12, s12, 4096
    v_mul_f32 v133, v118, v177
    v_mul_f32 v134, v118, v178
    v_mfma_f32_16x16x32_bf16 v[144:147], a[88:91], v[84:87], v[144:147]
    ds_read_b128 v[68:71], v7 offset:18432
    v_mul_f32 v135, v118, v179
    v_mfma_f32_16x16x32_bf16 v[128:131], a[72:75], v[80:83], v[128:131]
    v_mul_f32 v148, v118, v180
    v_mul_f32 v149, v118, v181
    v_mfma_f32_16x16x32_bf16 v[128:131], a[84:87], v[84:87], v[128:131]
    s_waitcnt lgkmcnt(2)
    v_mul_f32 v150, v118, v182
    v_mul_f32 v151, v118, v183
    v_mfma_f32_16x16x32_bf16 v[136:139], a[72:75], v[88:91], v[136:139]
    ds_read_b128 v[72:75], v7 offset:49152
    v_mul_f32 v164, v118, v184
    v_mfma_f32_16x16x32_bf16 v[136:139], a[84:87], v[92:95], v[136:139]
    buffer_load_dwordx4 v[208:211], v13, s[64:67], s12 offen
    v_mfma_f32_16x16x32_bf16 v[152:155], a[76:79], v[88:91], v[152:155]
    v_mul_f32 v165, v118, v185
    v_mul_f32 v166, v118, v186
    v_mfma_f32_16x16x32_bf16 v[152:155], a[88:91], v[92:95], v[152:155]
    ds_read_b128 v[76:79], v7 offset:51200
    v_mul_f32 v167, v118, v187
    v_mfma_f32_16x16x32_bf16 v[168:171], a[80:83], v[88:91], v[168:171]
    v_mul_f32 v140, v119, v176
    v_mul_f32 v141, v119, v177
    v_mfma_f32_16x16x32_bf16 v[168:171], a[92:95], v[92:95], v[168:171]
    s_waitcnt lgkmcnt(2)
    v_mul_f32 v142, v119, v178
    v_mul_f32 v143, v119, v179
    v_mfma_f32_16x16x32_bf16 v[160:163], a[104:107], v[64:67], v[160:163]
    ds_read_b128 v[80:83], v7 offset:20480
    v_mul_f32 v156, v119, v180
    v_mfma_f32_16x16x32_bf16 v[160:163], a[116:119], v[68:71], v[160:163]
    buffer_load_dwordx4 v[212:215], v14, s[64:67], s12 offen
    v_mfma_f32_16x16x32_bf16 v[144:147], a[100:103], v[64:67], v[144:147]
    v_mul_f32 v157, v119, v181
    v_mul_f32 v158, v119, v182
    v_mfma_f32_16x16x32_bf16 v[144:147], a[112:115], v[68:71], v[144:147]
    ds_read_b128 v[84:87], v7 offset:22528
    v_mul_f32 v159, v119, v183
    v_mfma_f32_16x16x32_bf16 v[128:131], a[96:99], v[64:67], v[128:131]
    v_mul_f32 v172, v119, v184
    v_mul_f32 v173, v119, v185
    v_mfma_f32_16x16x32_bf16 v[128:131], a[108:111], v[68:71], v[128:131]
    s_waitcnt lgkmcnt(2)
    v_mul_f32 v174, v119, v186
    v_mul_f32 v175, v119, v187
    v_mfma_f32_16x16x32_bf16 v[136:139], a[96:99], v[72:75], v[136:139]
    ds_read_b128 v[88:91], v7 offset:53248
    v_add_u32 v1, 56320, v1
    v_mfma_f32_16x16x32_bf16 v[136:139], a[108:111], v[76:79], v[136:139]
    buffer_load_dwordx4 v[216:219], v112, s[64:67], s12 offen
    v_mfma_f32_16x16x32_bf16 v[152:155], a[100:103], v[72:75], v[152:155]
    v_add_u32 v2, 56320, v2
    v_add_u32 v3, 56320, v3
    v_mfma_f32_16x16x32_bf16 v[152:155], a[112:115], v[76:79], v[152:155]
    ds_read_b128 v[92:95], v7 offset:55296
    v_add_u32 v4, 56320, v4
    v_mfma_f32_16x16x32_bf16 v[168:171], a[104:107], v[72:75], v[168:171]
    v_and_b32 v122, 15, v0
    v_lshl_add_u32 v122, v122, 4, s86
    v_mfma_f32_16x16x32_bf16 v[168:171], a[116:119], v[76:79], v[168:171]
    s_waitcnt lgkmcnt(2)
    v_lshrrev_b32 v127, 5, v0
    v_lshl_add_u32 v122, v127, 9, v122
    v_mfma_f32_16x16x32_bf16 v[160:163], a[128:131], v[80:83], v[160:163]
    ds_read_b128 v[64:67], v7 offset:24576
    v_bfe_u32 v127, v0, 4, 1
    v_mfma_f32_16x16x32_bf16 v[160:163], a[140:143], v[84:87], v[160:163]
    buffer_load_dwordx4 v[220:223], v113, s[64:67], s12 offen
    v_mfma_f32_16x16x32_bf16 v[144:147], a[124:127], v[80:83], v[144:147]
    s_lshl1_add_u32 s12, s55, s26
    v_lshl_add_u32 v122, v127, 3, v122
    v_add_u32 v127, 65536, v122
    v_mfma_f32_16x16x32_bf16 v[144:147], a[136:139], v[84:87], v[144:147]
    ds_read_b128 v[68:71], v7 offset:26624
    ds_read2_b64 v[96:99], v122 offset1:32
    v_mfma_f32_16x16x32_bf16 v[128:131], a[120:123], v[80:83], v[128:131]
    s_mul_i32 s72, s68, 8160
    ds_read2_b64 v[100:103], v127 offset1:32
    v_mfma_f32_16x16x32_bf16 v[128:131], a[132:135], v[84:87], v[128:131]
    s_waitcnt lgkmcnt(4)
    v_mfma_f32_16x16x32_bf16 v[136:139], a[120:123], v[88:91], v[136:139]
    s_mul_i32 s86, s68, 1152
    ds_read_b128 v[72:75], v7 offset:57344
    v_mfma_f32_16x16x32_bf16 v[136:139], a[132:135], v[92:95], v[136:139]
    buffer_load_dwordx4 v[224:227], v13, s[64:67], s12 offen
    v_mfma_f32_16x16x32_bf16 v[152:155], a[124:127], v[88:91], v[152:155]
    v_and_b32 v123, 15, v0
    v_mul_u32_u24 v123, 144, v123
    v_mfma_f32_16x16x32_bf16 v[152:155], a[136:139], v[92:95], v[152:155]
    ds_read_b128 v[76:79], v7 offset:59392
    v_lshl_add_u32 v123, s68, 5, v123
    v_mfma_f32_16x16x32_bf16 v[168:171], a[128:131], v[88:91], v[168:171]
    v_lshrrev_b32 v124, 5, v0
    v_lshl_add_u32 v123, v124, 3, v123
    v_mfma_f32_16x16x32_bf16 v[168:171], a[140:143], v[92:95], v[168:171]
    s_waitcnt lgkmcnt(4)
    v_and_b32 v124, 16, v0
    v_add_u32 v123, v123, v124
    v_mfma_f32_16x16x32_bf16 v[160:163], a[152:155], v[64:67], v[160:163]
    ds_read_b128 v[80:83], v7 offset:28672
    v_lshrrev_b32 v124, 3, v0
    v_mfma_f32_16x16x32_bf16 v[160:163], a[164:167], v[68:71], v[160:163]
    buffer_load_dwordx4 v[228:231], v14, s[64:67], s12 offen
    v_mfma_f32_16x16x32_bf16 v[144:147], a[148:151], v[64:67], v[144:147]
    v_mul_u32_u24 v125, 896, v124
    v_add3_u32 v125, v125, s72, v12
    v_mfma_f32_16x16x32_bf16 v[144:147], a[160:163], v[68:71], v[144:147]
    ds_read_b128 v[84:87], v7 offset:30720
    v_lshl_add_u32 v124, v124, 4, v12
    v_mfma_f32_16x16x32_bf16 v[128:131], a[144:147], v[64:67], v[128:131]
    v_add_u32 v124, s86, v124
    v_mfma_f32_16x16x32_bf16 v[128:131], a[156:159], v[68:71], v[128:131]
    s_waitcnt lgkmcnt(2)
    v_mfma_f32_16x16x32_bf16 v[136:139], a[144:147], v[72:75], v[136:139]
    s_waitcnt vmcnt(7)
    ds_read_b128 v[88:91], v7 offset:61440
    buffer_store_dwordx2 v[106:107], v5, s[64:67], s14 offen offset:0
    v_mfma_f32_16x16x32_bf16 v[136:139], a[156:159], v[76:79], v[136:139]
    s_cmp_lg_u32 s17, 0
    s_cbranch_scc1 FG_26
FR_27:
    v_mfma_f32_16x16x32_bf16 v[152:155], a[148:151], v[72:75], v[152:155]
    buffer_load_dwordx4 v[232:235], v112, s[64:67], s12 offen
    v_mfma_f32_16x16x32_bf16 v[152:155], a[160:163], v[76:79], v[152:155]
    ds_read_b128 v[92:95], v7 offset:63488
    v_mfma_f32_16x16x32_bf16 v[168:171], a[152:155], v[72:75], v[168:171]
    v_mfma_f32_16x16x32_bf16 v[168:171], a[164:167], v[76:79], v[168:171]
    s_waitcnt lgkmcnt(2)
    v_mfma_f32_16x16x32_bf16 v[160:163], a[176:179], v[80:83], v[160:163]
    ds_read_b128 v[64:67], v7 offset:256
    v_mfma_f32_16x16x32_bf16 v[160:163], a[188:191], v[84:87], v[160:163]
    buffer_load_dwordx4 v[236:239], v113, s[64:67], s12 offen
    v_mfma_f32_16x16x32_bf16 v[144:147], a[172:175], v[80:83], v[144:147]
    s_add_u32 s12, s12, 4096
    v_mfma_f32_16x16x32_bf16 v[144:147], a[184:187], v[84:87], v[144:147]
    ds_read_b128 v[68:71], v7 offset:2304
    v_mfma_f32_16x16x32_bf16 v[128:131], a[168:171], v[80:83], v[128:131]
    v_mfma_f32_16x16x32_bf16 v[128:131], a[180:183], v[84:87], v[128:131]
    s_waitcnt lgkmcnt(2)
    v_mfma_f32_16x16x32_bf16 v[136:139], a[168:171], v[88:91], v[136:139]
    ds_read_b128 v[72:75], v7 offset:33024
    v_mfma_f32_16x16x32_bf16 v[136:139], a[180:183], v[92:95], v[136:139]
    buffer_load_dwordx4 v[240:243], v13, s[64:67], s12 offen
    v_mfma_f32_16x16x32_bf16 v[152:155], a[172:175], v[88:91], v[152:155]
    v_mfma_f32_16x16x32_bf16 v[152:155], a[184:187], v[92:95], v[152:155]
    ds_read_b128 v[76:79], v7 offset:35072
    v_mfma_f32_16x16x32_bf16 v[168:171], a[176:179], v[88:91], v[168:171]
    v_mfma_f32_16x16x32_bf16 v[168:171], a[188:191], v[92:95], v[168:171]
    s_waitcnt lgkmcnt(2)
    v_mfma_f32_16x16x32_bf16 v[164:167], a[8:11], v[64:67], v[164:167]
    ds_read_b128 v[80:83], v7 offset:4352
    v_mfma_f32_16x16x32_bf16 v[164:167], a[20:23], v[68:71], v[164:167]
    buffer_load_dwordx4 v[244:247], v14, s[64:67], s12 offen
    v_mfma_f32_16x16x32_bf16 v[148:151], a[4:7], v[64:67], v[148:151]
    v_mul_f32 v144, v128, v144
    v_mul_f32 v145, v129, v145
    v_mfma_f32_16x16x32_bf16 v[148:151], a[16:19], v[68:71], v[148:151]
    ds_read_b128 v[84:87], v7 offset:6400
    v_mul_f32 v146, v130, v146
    v_mfma_f32_16x16x32_bf16 v[132:135], a[0:3], v[64:67], v[132:135]
    v_permlane16_swap_b32 v160, v162
    v_mfma_f32_16x16x32_bf16 v[132:135], a[12:15], v[68:71], v[132:135]
    s_waitcnt lgkmcnt(2)
    v_permlane16_swap_b32 v161, v163
    v_mfma_f32_16x16x32_bf16 v[140:143], a[0:3], v[72:75], v[140:143]
    ds_read_b128 v[88:91], v7 offset:37120
    v_mul_f32 v147, v131, v147
    v_mfma_f32_16x16x32_bf16 v[140:143], a[12:15], v[76:79], v[140:143]
    buffer_load_dwordx4 v[248:251], v112, s[64:67], s12 offen
    v_mfma_f32_16x16x32_bf16 v[156:159], a[4:7], v[72:75], v[156:159]
    v_permlane16_swap_b32 v168, v170
    v_mfma_f32_16x16x32_bf16 v[156:159], a[16:19], v[76:79], v[156:159]
    ds_read_b128 v[92:95], v7 offset:39168
    v_mul_f32 v152, v136, v152
    v_mfma_f32_16x16x32_bf16 v[172:175], a[8:11], v[72:75], v[172:175]
    buffer_load_dwordx2 v[120:121], v15, s[64:67], s10 offen offset:0 sc1
    v_mfma_f32_16x16x32_bf16 v[172:175], a[20:23], v[76:79], v[172:175]
    s_waitcnt lgkmcnt(2)
    v_permlane16_swap_b32 v169, v171
    v_mfma_f32_16x16x32_bf16 v[164:167], a[32:35], v[80:83], v[164:167]
    ds_read_b128 v[64:67], v7 offset:8448
    v_mul_f32 v153, v137, v153
    v_mfma_f32_16x16x32_bf16 v[164:167], a[44:47], v[84:87], v[164:167]
    buffer_load_dwordx4 v[252:255], v113, s[64:67], s12 offen
    v_mfma_f32_16x16x32_bf16 v[148:151], a[28:31], v[80:83], v[148:151]
    s_add_u32 s12, s26, 32768
    v_mul_f32 v154, v138, v154
    v_mul_f32 v155, v139, v155
    v_mfma_f32_16x16x32_bf16 v[148:151], a[40:43], v[84:87], v[148:151]
    ds_read_b128 v[68:71], v7 offset:10496
    v_cvt_pk_bf16_f32 v128, v144, v145
    v_mfma_f32_16x16x32_bf16 v[132:135], a[24:27], v[80:83], v[132:135]
    v_cvt_pk_bf16_f32 v129, v146, v147
    v_cvt_pk_bf16_f32 v130, v152, v153
    v_mfma_f32_16x16x32_bf16 v[132:135], a[36:39], v[84:87], v[132:135]
    s_waitcnt lgkmcnt(2)
    v_cvt_pk_bf16_f32 v131, v154, v155
    v_mul_f32 v160, v160, v162
    v_mfma_f32_16x16x32_bf16 v[140:143], a[24:27], v[88:91], v[140:143]
    ds_read_b128 v[72:75], v7 offset:41216
    v_mul_f32 v161, v161, v163
    v_mfma_f32_16x16x32_bf16 v[140:143], a[36:39], v[92:95], v[140:143]
    buffer_load_dwordx4 v[16:19], v13, s[64:67], s12 offen
    v_mfma_f32_16x16x32_bf16 v[156:159], a[28:31], v[88:91], v[156:159]
    v_mul_f32 v168, v168, v170
    v_mul_f32 v169, v169, v171
    v_mfma_f32_16x16x32_bf16 v[156:159], a[40:43], v[92:95], v[156:159]
    ds_read_b128 v[76:79], v7 offset:43264
    v_cvt_pk_bf16_f32 v136, v160, v161
    v_mfma_f32_16x16x32_bf16 v[172:175], a[32:35], v[88:91], v[172:175]
    v_cvt_pk_bf16_f32 v137, v168, v169
    v_mfma_f32_16x16x32_bf16 v[172:175], a[44:47], v[92:95], v[172:175]
    s_waitcnt lgkmcnt(2)
    v_permlane16_swap_b32 v128, v130
    v_mfma_f32_16x16x32_bf16 v[164:167], a[56:59], v[64:67], v[164:167]
    ds_read_b128 v[80:83], v7 offset:12544
    v_mfma_f32_16x16x32_bf16 v[164:167], a[68:71], v[68:71], v[164:167]
    buffer_load_dwordx4 v[20:23], v14, s[64:67], s12 offen
    v_mfma_f32_16x16x32_bf16 v[148:151], a[52:55], v[64:67], v[148:151]
    v_permlane16_swap_b32 v129, v131
    v_mfma_f32_16x16x32_bf16 v[148:151], a[64:67], v[68:71], v[148:151]
    ds_read_b128 v[84:87], v7 offset:14592
    v_mfma_f32_16x16x32_bf16 v[132:135], a[48:51], v[64:67], v[132:135]
    buffer_store_dwordx4 v[128:131], v104, s[64:67], s87 offen offset:0 sc1
    v_mfma_f32_16x16x32_bf16 v[132:135], a[60:63], v[68:71], v[132:135]
    s_waitcnt lgkmcnt(2)
    v_permlane16_swap_b32 v136, v137
    v_mfma_f32_16x16x32_bf16 v[140:143], a[48:51], v[72:75], v[140:143]
    ds_read_b128 v[88:91], v7 offset:45312
    v_mfma_f32_16x16x32_bf16 v[140:143], a[60:63], v[76:79], v[140:143]
    buffer_load_dwordx4 v[24:27], v112, s[64:67], s12 offen
    v_mfma_f32_16x16x32_bf16 v[156:159], a[52:55], v[72:75], v[156:159]
    buffer_store_dwordx2 v[136:137], v105, s[64:67], s87 offen offset:1024 sc1
    v_mfma_f32_16x16x32_bf16 v[156:159], a[64:67], v[76:79], v[156:159]
    ds_read_b128 v[92:95], v7 offset:47360
    ds_read2_b32 v[116:117], v8 offset1:16
    v_mfma_f32_16x16x32_bf16 v[172:175], a[56:59], v[72:75], v[172:175]
    ds_read2_b32 v[118:119], v8 offset0:64 offset1:80
    v_lshlrev_b32 v184, 16, v96
    v_mfma_f32_16x16x32_bf16 v[172:175], a[68:71], v[76:79], v[172:175]
    s_waitcnt lgkmcnt(4)
    v_and_b32 v185, 0xffff0000, v96
    v_lshlrev_b32 v186, 16, v97
    v_mfma_f32_16x16x32_bf16 v[164:167], a[80:83], v[80:83], v[164:167]
    ds_read_b128 v[64:67], v7 offset:16640
    v_and_b32 v187, 0xffff0000, v97
    v_mfma_f32_16x16x32_bf16 v[164:167], a[92:95], v[84:87], v[164:167]
    buffer_load_dwordx4 v[28:31], v113, s[64:67], s12 offen
    v_mfma_f32_16x16x32_bf16 v[148:151], a[76:79], v[80:83], v[148:151]
    s_add_u32 s12, s12, 4096
    v_lshlrev_b32 v188, 16, v98
    v_and_b32 v189, 0xffff0000, v98
    v_mfma_f32_16x16x32_bf16 v[148:151], a[88:91], v[84:87], v[148:151]
    ds_read_b128 v[68:71], v7 offset:18688
    v_lshlrev_b32 v190, 16, v99
    v_mfma_f32_16x16x32_bf16 v[132:135], a[72:75], v[80:83], v[132:135]
    v_and_b32 v191, 0xffff0000, v99
    v_mfma_f32_16x16x32_bf16 v[132:135], a[84:87], v[84:87], v[132:135]
    s_waitcnt lgkmcnt(4)
    v_mfma_f32_16x16x32_bf16 v[140:143], a[72:75], v[88:91], v[140:143]
    ds_read_b128 v[72:75], v7 offset:49408
    v_mfma_f32_16x16x32_bf16 v[140:143], a[84:87], v[92:95], v[140:143]
    buffer_load_dwordx4 v[32:35], v13, s[64:67], s12 offen
    v_mfma_f32_16x16x32_bf16 v[156:159], a[76:79], v[88:91], v[156:159]
    v_mfma_f32_16x16x32_bf16 v[156:159], a[88:91], v[92:95], v[156:159]
    ds_read_b128 v[76:79], v7 offset:51456
    v_mfma_f32_16x16x32_bf16 v[172:175], a[80:83], v[88:91], v[172:175]
    s_waitcnt vmcnt(8)
    v_cmp_ne_u64 vcc, s[18:19], v[120:121]
    v_mfma_f32_16x16x32_bf16 v[172:175], a[92:95], v[92:95], v[172:175]
    s_waitcnt lgkmcnt(2)
    v_mfma_f32_16x16x32_bf16 v[164:167], a[104:107], v[64:67], v[164:167]
    ds_read_b128 v[80:83], v7 offset:20736
    v_mfma_f32_16x16x32_bf16 v[164:167], a[116:119], v[68:71], v[164:167]
    s_cbranch_vccnz PS_34
PR_35:
    v_mfma_f32_16x16x32_bf16 v[148:151], a[100:103], v[64:67], v[148:151]
    buffer_load_dwordx4 a[0:3], v6, s[64:67], s13 offen offset:0
    v_mfma_f32_16x16x32_bf16 v[148:151], a[112:115], v[68:71], v[148:151]
    ds_read_b128 v[84:87], v7 offset:22784
    v_mfma_f32_16x16x32_bf16 v[132:135], a[96:99], v[64:67], v[132:135]
    buffer_load_dwordx4 a[4:7], v6, s[64:67], s13 offen offset:2048
    v_mfma_f32_16x16x32_bf16 v[132:135], a[108:111], v[68:71], v[132:135]
    s_waitcnt lgkmcnt(2)
    v_mfma_f32_16x16x32_bf16 v[140:143], a[96:99], v[72:75], v[140:143]
    ds_read_b128 v[88:91], v7 offset:53504
    v_mfma_f32_16x16x32_bf16 v[140:143], a[108:111], v[76:79], v[140:143]
    v_mfma_f32_16x16x32_bf16 v[156:159], a[100:103], v[72:75], v[156:159]
    buffer_load_dwordx4 v[36:39], v14, s[64:67], s12 offen
    v_mfma_f32_16x16x32_bf16 v[156:159], a[112:115], v[76:79], v[156:159]
    ds_read_b128 v[92:95], v7 offset:55552
    v_mfma_f32_16x16x32_bf16 v[172:175], a[104:107], v[72:75], v[172:175]
    v_mfma_f32_16x16x32_bf16 v[172:175], a[116:119], v[76:79], v[172:175]
    s_waitcnt lgkmcnt(2)
    v_mfma_f32_16x16x32_bf16 v[164:167], a[128:131], v[80:83], v[164:167]
    ds_read_b128 v[64:67], v7 offset:24832
    v_mfma_f32_16x16x32_bf16 v[164:167], a[140:143], v[84:87], v[164:167]
    buffer_load_dwordx4 a[8:11], v6, s[64:67], s13 offen offset:256
    v_mfma_f32_16x16x32_bf16 v[148:151], a[124:127], v[80:83], v[148:151]
    v_mfma_f32_16x16x32_bf16 v[148:151], a[136:139], v[84:87], v[148:151]
    ds_read_b128 v[68:71], v7 offset:26880
    v_mfma_f32_16x16x32_bf16 v[132:135], a[120:123], v[80:83], v[132:135]
    buffer_load_dwordx4 a[12:15], v6, s[64:67], s13 offen offset:2304
    v_mfma_f32_16x16x32_bf16 v[132:135], a[132:135], v[84:87], v[132:135]
    s_waitcnt lgkmcnt(2)
    v_mfma_f32_16x16x32_bf16 v[140:143], a[120:123], v[88:91], v[140:143]
    s_add_u32 s13, s83, s53
    ds_read_b128 v[72:75], v7 offset:28928
    v_mfma_f32_16x16x32_bf16 v[140:143], a[132:135], v[92:95], v[140:143]
    v_mfma_f32_16x16x32_bf16 v[156:159], a[124:127], v[88:91], v[156:159]
    buffer_load_dwordx4 v[40:43], v112, s[64:67], s12 offen
    v_mfma_f32_16x16x32_bf16 v[156:159], a[136:139], v[92:95], v[156:159]
    ds_read_b128 v[76:79], v7 offset:30976
    v_mfma_f32_16x16x32_bf16 v[172:175], a[128:131], v[88:91], v[172:175]
    v_mfma_f32_16x16x32_bf16 v[172:175], a[140:143], v[92:95], v[172:175]
    s_waitcnt lgkmcnt(2)
    v_mfma_f32_16x16x32_bf16 v[164:167], a[152:155], v[64:67], v[164:167]
HOP_6:
    s_cbranch_execz HR_11
    ds_read_b128 v[80:83], v7 offset:57600
    v_mfma_f32_16x16x32_bf16 v[164:167], a[164:167], v[68:71], v[164:167]
    buffer_load_dwordx4 a[16:19], v6, s[64:67], s13 offen offset:0
    v_mfma_f32_16x16x32_bf16 v[148:151], a[148:151], v[64:67], v[148:151]
    v_mfma_f32_16x16x32_bf16 v[148:151], a[160:163], v[68:71], v[148:151]
    ds_read_b128 v[84:87], v7 offset:59648
    v_mfma_f32_16x16x32_bf16 v[132:135], a[144:147], v[64:67], v[132:135]
    buffer_load_dwordx4 v[44:47], v113, s[64:67], s12 offen
    v_mfma_f32_16x16x32_bf16 v[132:135], a[156:159], v[68:71], v[132:135]
    s_waitcnt lgkmcnt(2)
    v_mfma_f32_16x16x32_bf16 v[132:135], a[168:171], v[72:75], v[132:135]
    s_add_u32 s12, s12, s91
    ds_read_b128 v[88:91], v7 offset:61696
    v_mfma_f32_16x16x32_bf16 v[132:135], a[180:183], v[76:79], v[132:135]
    buffer_load_dwordx4 a[20:23], v6, s[64:67], s13 offen offset:2048
    v_mfma_f32_16x16x32_bf16 v[148:151], a[172:175], v[72:75], v[148:151]
    v_mfma_f32_16x16x32_bf16 v[148:151], a[184:187], v[76:79], v[148:151]
    ds_read_b128 v[92:95], v7 offset:63744
    v_mfma_f32_16x16x32_bf16 v[164:167], a[176:179], v[72:75], v[164:167]
    s_waitcnt vmcnt(11)
    buffer_store_dwordx2 v[106:107], v5, s[64:67], s14 offen offset:512
    v_mfma_f32_16x16x32_bf16 v[164:167], a[188:191], v[76:79], v[164:167]
    s_waitcnt lgkmcnt(2)
    v_mfma_f32_16x16x32_bf16 v[172:175], a[152:155], v[80:83], v[172:175]
    s_cmp_lg_u32 s17, 0
    s_cbranch_scc1 FG_28
FR_29:
    v_mfma_f32_16x16x32_bf16 v[172:175], a[164:167], v[84:87], v[172:175]
    buffer_load_dwordx4 v[48:51], v13, s[64:67], s12 offen
    v_mfma_f32_16x16x32_bf16 v[156:159], a[148:151], v[80:83], v[156:159]
    buffer_load_dwordx4 a[24:27], v6, s[64:67], s13 offen offset:256
    v_mfma_f32_16x16x32_bf16 v[156:159], a[160:163], v[84:87], v[156:159]
    v_mul_f32 v148, v132, v148
    v_mul_f32 v149, v133, v149
    v_mfma_f32_16x16x32_bf16 v[140:143], a[144:147], v[80:83], v[140:143]
    buffer_load_dwordx4 a[28:31], v6, s[64:67], s13 offen offset:2304
    v_mfma_f32_16x16x32_bf16 v[140:143], a[156:159], v[84:87], v[140:143]
    s_waitcnt lgkmcnt(0)
    v_mul_f32 v150, v134, v150
    v_mul_f32 v151, v135, v151
    v_mfma_f32_16x16x32_bf16 v[140:143], a[168:171], v[88:91], v[140:143]
    s_add_u32 s13, s83, s54
    v_cvt_pk_bf16_f32 v132, v148, v149
    v_cvt_pk_bf16_f32 v133, v150, v151
    v_mfma_f32_16x16x32_bf16 v[140:143], a[180:183], v[92:95], v[140:143]
    buffer_load_dwordx4 a[32:35], v6, s[64:67], s13 offen offset:0
    v_mfma_f32_16x16x32_bf16 v[156:159], a[172:175], v[88:91], v[156:159]
    v_permlane16_swap_b32 v164, v166
    v_mfma_f32_16x16x32_bf16 v[156:159], a[184:187], v[92:95], v[156:159]
    v_permlane16_swap_b32 v165, v167
    v_mfma_f32_16x16x32_bf16 v[172:175], a[176:179], v[88:91], v[172:175]
    buffer_load_dwordx4 v[52:55], v14, s[64:67], s12 offen
    v_mfma_f32_16x16x32_bf16 v[172:175], a[188:191], v[92:95], v[172:175]
    s_waitcnt vmcnt(13)
    v_mul_f32 v164, v164, v166
    v_mul_f32 v165, v165, v167
    v_mfma_f32_16x16x32_bf16 v[64:67], a[192:195], a[0:3], 0
    buffer_load_dwordx4 a[36:39], v6, s[64:67], s13 offen offset:2048
    v_mfma_f32_16x16x32_bf16 v[64:67], a[208:211], a[4:7], v[64:67]
    v_mfma_f32_16x16x32_bf16 v[72:75], a[196:199], a[0:3], 0
    v_mfma_f32_16x16x32_bf16 v[72:75], a[212:215], a[4:7], v[72:75]
    v_mul_f32 v156, v140, v156
    v_mul_f32 v157, v141, v157
    v_mfma_f32_16x16x32_bf16 v[80:83], a[200:203], a[0:3], 0
    buffer_load_dwordx4 a[40:43], v6, s[64:67], s13 offen offset:256
    v_mfma_f32_16x16x32_bf16 v[80:83], a[216:219], a[4:7], v[80:83]
    v_mul_f32 v158, v142, v158
    v_mul_f32 v159, v143, v159
    v_mfma_f32_16x16x32_bf16 v[88:91], a[204:207], a[0:3], 0
    v_cvt_pk_bf16_f32 v134, v156, v157
    v_cvt_pk_bf16_f32 v135, v158, v159
    v_mfma_f32_16x16x32_bf16 v[88:91], a[220:223], a[4:7], v[88:91]
    s_waitcnt vmcnt(12)
    v_permlane16_swap_b32 v132, v134
    v_mfma_f32_16x16x32_bf16 v[68:71], a[192:195], a[8:11], 0
    buffer_load_dwordx4 a[44:47], v6, s[64:67], s13 offen offset:2304
    v_mfma_f32_16x16x32_bf16 v[68:71], a[208:211], a[12:15], v[68:71]
    s_add_u32 s13, s83, s55
    v_permlane16_swap_b32 v133, v135
    v_mfma_f32_16x16x32_bf16 v[76:79], a[196:199], a[8:11], 0
    buffer_store_dwordx4 v[132:135], v104, s[64:67], s87 offen offset:256 sc1
    v_mfma_f32_16x16x32_bf16 v[76:79], a[212:215], a[12:15], v[76:79]
    v_permlane16_swap_b32 v172, v174
    v_mfma_f32_16x16x32_bf16 v[84:87], a[200:203], a[8:11], 0
    buffer_load_dwordx4 a[48:51], v6, s[64:67], s13 offen offset:0
    v_mfma_f32_16x16x32_bf16 v[84:87], a[216:219], a[12:15], v[84:87]
    v_permlane16_swap_b32 v173, v175
    v_mfma_f32_16x16x32_bf16 v[92:95], a[204:207], a[8:11], 0
    v_mul_f32 v172, v172, v174
    v_mul_f32 v173, v173, v175
    v_mfma_f32_16x16x32_bf16 v[92:95], a[220:223], a[12:15], v[92:95]
    s_waitcnt vmcnt(11)
    v_cvt_pk_bf16_f32 v140, v164, v165
    v_cvt_pk_bf16_f32 v141, v172, v173
    v_mfma_f32_16x16x32_bf16 v[64:67], a[224:227], a[16:19], v[64:67]
    buffer_load_dwordx4 a[52:55], v6, s[64:67], s13 offen offset:2048
    v_mfma_f32_16x16x32_bf16 v[64:67], a[240:243], a[20:23], v[64:67]
    v_permlane16_swap_b32 v140, v141
    v_mfma_f32_16x16x32_bf16 v[72:75], a[228:231], a[16:19], v[72:75]
    buffer_load_dwordx2 v[120:121], v15, s[64:67], s10 offen offset:512 sc1
    v_mfma_f32_16x16x32_bf16 v[72:75], a[244:247], a[20:23], v[72:75]
    buffer_store_dwordx2 v[140:141], v105, s[64:67], s87 offen offset:1280 sc1
    v_mfma_f32_16x16x32_bf16 v[80:83], a[232:235], a[16:19], v[80:83]
    buffer_load_dwordx4 v[56:59], v112, s[64:67], s12 offen
    v_mfma_f32_16x16x32_bf16 v[80:83], a[248:251], a[20:23], v[80:83]
    v_mfma_f32_16x16x32_bf16 v[88:91], a[236:239], a[16:19], v[88:91]
    v_mfma_f32_16x16x32_bf16 v[88:91], a[252:255], a[20:23], v[88:91]
    s_waitcnt vmcnt(11)
    v_mfma_f32_16x16x32_bf16 v[68:71], a[224:227], a[24:27], v[68:71]
    buffer_load_dwordx4 a[56:59], v6, s[64:67], s13 offen offset:256
    v_mfma_f32_16x16x32_bf16 v[68:71], a[240:243], a[28:31], v[68:71]
    v_mfma_f32_16x16x32_bf16 v[76:79], a[228:231], a[24:27], v[76:79]
    v_mfma_f32_16x16x32_bf16 v[76:79], a[244:247], a[28:31], v[76:79]
    v_mfma_f32_16x16x32_bf16 v[84:87], a[232:235], a[24:27], v[84:87]
    buffer_load_dwordx4 a[60:63], v6, s[64:67], s13 offen offset:2304
    v_mfma_f32_16x16x32_bf16 v[84:87], a[248:251], a[28:31], v[84:87]
    s_add_u32 s13, s83, 16384
    v_mfma_f32_16x16x32_bf16 v[92:95], a[236:239], a[24:27], v[92:95]
    v_mfma_f32_16x16x32_bf16 v[92:95], a[252:255], a[28:31], v[92:95]
    s_waitcnt vmcnt(10)
    v_mfma_f32_16x16x32_bf16 v[64:67], v[192:195], a[32:35], v[64:67]
    buffer_load_dwordx4 v[60:63], v113, s[64:67], s12 offen
    v_mfma_f32_16x16x32_bf16 v[64:67], v[208:211], a[36:39], v[64:67]
    v_mfma_f32_16x16x32_bf16 v[72:75], v[196:199], a[32:35], v[72:75]
    v_mfma_f32_16x16x32_bf16 v[72:75], v[212:215], a[36:39], v[72:75]
    v_mfma_f32_16x16x32_bf16 v[80:83], v[200:203], a[32:35], v[80:83]
    buffer_load_dwordx4 a[64:67], v6, s[64:67], s13 offen offset:0
    v_mfma_f32_16x16x32_bf16 v[80:83], v[216:219], a[36:39], v[80:83]
    v_mfma_f32_16x16x32_bf16 v[88:91], v[204:207], a[32:35], v[88:91]
    buffer_load_dwordx4 a[68:71], v6, s[64:67], s13 offen offset:2048
    v_mfma_f32_16x16x32_bf16 v[88:91], v[220:223], a[36:39], v[88:91]
    s_waitcnt vmcnt(11)
    v_mfma_f32_16x16x32_bf16 v[68:71], v[192:195], a[40:43], v[68:71]
    v_mfma_f32_16x16x32_bf16 v[68:71], v[208:211], a[44:47], v[68:71]
    v_mfma_f32_16x16x32_bf16 v[76:79], v[196:199], a[40:43], v[76:79]
    buffer_load_dwordx4 a[72:75], v6, s[64:67], s13 offen offset:256
    v_mfma_f32_16x16x32_bf16 v[76:79], v[212:215], a[44:47], v[76:79]
    s_waitcnt vmcnt(7)
    buffer_store_dwordx2 v[106:107], v5, s[64:67], s14 offen offset:1024
    v_mfma_f32_16x16x32_bf16 v[84:87], v[200:203], a[40:43], v[84:87]
    s_cmp_lg_u32 s17, 0
    s_cbranch_scc1 FG_30
FR_31:
    v_mfma_f32_16x16x32_bf16 v[84:87], v[216:219], a[44:47], v[84:87]
    v_cmp_ne_u64 vcc, s[18:19], v[120:121]
    v_mfma_f32_16x16x32_bf16 v[92:95], v[204:207], a[40:43], v[92:95]
    buffer_load_dwordx4 a[76:79], v6, s[64:67], s13 offen offset:2304
    v_mfma_f32_16x16x32_bf16 v[92:95], v[220:223], a[44:47], v[92:95]
    v_mfma_f32_16x16x32_bf16 v[64:67], v[224:227], a[48:51], v[64:67]
    s_nop 0
    s_cbranch_vccnz PS_36
PR_37:
    v_mfma_f32_16x16x32_bf16 v[64:67], v[240:243], a[52:55], v[64:67]
    s_add_u32 s13, s83, 20480
    v_mfma_f32_16x16x32_bf16 v[72:75], v[228:231], a[48:51], v[72:75]
    buffer_load_dwordx4 a[80:83], v114, s[64:67], s13 offen offset:0
    v_mfma_f32_16x16x32_bf16 v[72:75], v[244:247], a[52:55], v[72:75]
    v_mfma_f32_16x16x32_bf16 v[80:83], v[232:235], a[48:51], v[80:83]
    buffer_load_dwordx4 a[84:87], v114, s[64:67], s13 offen offset:256
    v_mfma_f32_16x16x32_bf16 v[80:83], v[248:251], a[52:55], v[80:83]
    s_add_u32 s13, s84, s52
    v_mfma_f32_16x16x32_bf16 v[88:91], v[236:239], a[48:51], v[88:91]
    v_mfma_f32_16x16x32_bf16 v[88:91], v[252:255], a[52:55], v[88:91]
    s_waitcnt vmcnt(8)
    v_mfma_f32_16x16x32_bf16 v[68:71], v[224:227], a[56:59], v[68:71]
    buffer_load_dwordx4 a[88:91], v6, s[64:67], s13 offen offset:0
    v_mfma_f32_16x16x32_bf16 v[68:71], v[240:243], a[60:63], v[68:71]
    v_mfma_f32_16x16x32_bf16 v[76:79], v[228:231], a[56:59], v[76:79]
    v_mfma_f32_16x16x32_bf16 v[76:79], v[244:247], a[60:63], v[76:79]
    v_mfma_f32_16x16x32_bf16 v[84:87], v[232:235], a[56:59], v[84:87]
    buffer_load_dwordx4 a[92:95], v6, s[64:67], s13 offen offset:2048
    v_mfma_f32_16x16x32_bf16 v[84:87], v[248:251], a[60:63], v[84:87]
    s_add_u32 s13, s84, s53
    v_mfma_f32_16x16x32_bf16 v[92:95], v[236:239], a[56:59], v[92:95]
    v_mfma_f32_16x16x32_bf16 v[92:95], v[252:255], a[60:63], v[92:95]
    s_waitcnt vmcnt(7)
    v_mfma_f32_16x16x32_bf16 v[64:67], v[16:19], a[64:67], v[64:67]
    buffer_load_dwordx4 a[96:99], v6, s[64:67], s13 offen offset:0
    v_mfma_f32_16x16x32_bf16 v[64:67], v[32:35], a[68:71], v[64:67]
    v_mfma_f32_16x16x32_bf16 v[72:75], v[20:23], a[64:67], v[72:75]
    v_mfma_f32_16x16x32_bf16 v[72:75], v[36:39], a[68:71], v[72:75]
    v_mfma_f32_16x16x32_bf16 v[80:83], v[24:27], a[64:67], v[80:83]
    buffer_load_dwordx4 a[100:103], v6, s[64:67], s13 offen offset:2048
    v_mfma_f32_16x16x32_bf16 v[80:83], v[40:43], a[68:71], v[80:83]
    s_add_u32 s13, s84, s54
    v_mfma_f32_16x16x32_bf16 v[88:91], v[28:31], a[64:67], v[88:91]
    buffer_load_dwordx2 v[120:121], v15, s[64:67], s10 offen offset:1024 sc1
    v_mfma_f32_16x16x32_bf16 v[88:91], v[44:47], a[68:71], v[88:91]
    s_waitcnt vmcnt(7)
    v_mfma_f32_16x16x32_bf16 v[68:71], v[16:19], a[72:75], v[68:71]
    buffer_load_dwordx4 a[104:107], v6, s[64:67], s13 offen offset:0
    v_mfma_f32_16x16x32_bf16 v[68:71], v[32:35], a[76:79], v[68:71]
    v_mfma_f32_16x16x32_bf16 v[76:79], v[20:23], a[72:75], v[76:79]
    v_mfma_f32_16x16x32_bf16 v[76:79], v[36:39], a[76:79], v[76:79]
    v_mfma_f32_16x16x32_bf16 v[84:87], v[24:27], a[72:75], v[84:87]
    buffer_load_dwordx4 a[108:111], v6, s[64:67], s13 offen offset:2048
    v_mfma_f32_16x16x32_bf16 v[84:87], v[40:43], a[76:79], v[84:87]
    s_add_u32 s13, s84, s55
    v_mfma_f32_16x16x32_bf16 v[92:95], v[28:31], a[72:75], v[92:95]
    v_mfma_f32_16x16x32_bf16 v[92:95], v[44:47], a[76:79], v[92:95]
    s_waitcnt vmcnt(8)
    v_mfma_f32_16x16x32_bf16 v[64:67], v[48:51], a[80:83], v[64:67]
    buffer_load_dwordx4 a[112:115], v6, s[64:67], s13 offen offset:0
    v_mfma_f32_16x16x32_bf16 v[72:75], v[52:55], a[80:83], v[72:75]
    v_mfma_f32_16x16x32_bf16 v[80:83], v[56:59], a[80:83], v[80:83]
    v_mfma_f32_16x16x32_bf16 v[88:91], v[60:63], a[80:83], v[88:91]
    s_waitcnt vmcnt(8)
    v_mfma_f32_16x16x32_bf16 v[68:71], v[48:51], a[84:87], v[68:71]
    buffer_load_dwordx4 a[116:119], v6, s[64:67], s13 offen offset:2048
    v_mfma_f32_16x16x32_bf16 v[76:79], v[52:55], a[84:87], v[76:79]
    s_add_u32 s13, s84, 16384
    v_mfma_f32_16x16x32_bf16 v[84:87], v[56:59], a[84:87], v[84:87]
    v_mfma_f32_16x16x32_bf16 v[92:95], v[60:63], a[84:87], v[92:95]
    s_waitcnt vmcnt(8)
    v_mfma_f32_16x16x32_bf16 v[128:131], a[192:195], a[88:91], 0
    buffer_load_dwordx4 a[120:123], v6, s[64:67], s13 offen offset:0
    v_mfma_f32_16x16x32_bf16 v[136:139], a[196:199], a[88:91], 0
    v_mfma_f32_16x16x32_bf16 v[144:147], a[200:203], a[88:91], 0
    v_mfma_f32_16x16x32_bf16 v[152:155], a[204:207], a[88:91], 0
    s_waitcnt vmcnt(8)
    ds_write_b128 v1, v[72:75] offset:24576
    v_mfma_f32_16x16x32_bf16 v[128:131], a[208:211], a[92:95], v[128:131]
    buffer_load_dwordx4 a[124:127], v6, s[64:67], s13 offen offset:2048
    v_mfma_f32_16x16x32_bf16 v[136:139], a[212:215], a[92:95], v[136:139]
    s_add_u32 s13, s84, 20480
    ds_write_b128 v1, v[76:79] offset:25600
    v_mfma_f32_16x16x32_bf16 v[144:147], a[216:219], a[92:95], v[144:147]
    v_mfma_f32_16x16x32_bf16 v[152:155], a[220:223], a[92:95], v[152:155]
    s_waitcnt vmcnt(8)
    ds_write_b128 v2, v[80:83] offset:24576
    v_mfma_f32_16x16x32_bf16 v[128:131], a[224:227], a[96:99], v[128:131]
    buffer_load_dwordx4 a[128:131], v114, s[64:67], s13 offen offset:0
    v_mfma_f32_16x16x32_bf16 v[136:139], a[228:231], a[96:99], v[136:139]
    s_add_u32 s13, s84, s52
    ds_write_b128 v2, v[84:87] offset:25600
    v_mfma_f32_16x16x32_bf16 v[144:147], a[232:235], a[96:99], v[144:147]
    v_mfma_f32_16x16x32_bf16 v[152:155], a[236:239], a[96:99], v[152:155]
    s_waitcnt vmcnt(7)
    v_cmp_ne_u64 vcc, s[18:19], v[120:121]
    v_mfma_f32_16x16x32_bf16 v[128:131], a[240:243], a[100:103], v[128:131]
    ds_write_b128 v3, v[88:91] offset:24576
    v_mfma_f32_16x16x32_bf16 v[136:139], a[244:247], a[100:103], v[136:139]
    v_mfma_f32_16x16x32_bf16 v[144:147], a[248:251], a[100:103], v[144:147]
    s_nop 0
    s_cbranch_vccnz PS_38
PR_39:
    ds_write_b128 v3, v[92:95] offset:25600
    v_mfma_f32_16x16x32_bf16 v[152:155], a[252:255], a[100:103], v[152:155]
    s_waitcnt vmcnt(6)
    v_mfma_f32_16x16x32_bf16 v[128:131], v[192:195], a[104:107], v[128:131]
    buffer_load_dwordx4 a[132:135], v6, s[64:67], s13 offen offset:256
    v_mfma_f32_16x16x32_bf16 v[136:139], v[196:199], a[104:107], v[136:139]
    s_waitcnt lgkmcnt(0)
    s_barrier
    v_mfma_f32_16x16x32_bf16 v[144:147], v[200:203], a[104:107], v[144:147]
    buffer_load_dwordx4 a[136:139], v6, s[64:67], s13 offen offset:2304
    v_mfma_f32_16x16x32_bf16 v[152:155], v[204:207], a[104:107], v[152:155]
    s_waitcnt vmcnt(7)
    ds_read_b128 v[160:163], v4 offset:24576
    v_mfma_f32_16x16x32_bf16 v[128:131], v[208:211], a[108:111], v[128:131]
    s_add_u32 s13, s84, s53
    ds_read_b128 v[168:171], v4 offset:26624
    v_mfma_f32_16x16x32_bf16 v[136:139], v[212:215], a[108:111], v[136:139]
    buffer_load_dwordx4 a[140:143], v6, s[64:67], s13 offen offset:256
    v_mfma_f32_16x16x32_bf16 v[144:147], v[216:219], a[108:111], v[144:147]
    buffer_load_dwordx4 a[144:147], v6, s[64:67], s13 offen offset:2304
    v_mfma_f32_16x16x32_bf16 v[152:155], v[220:223], a[108:111], v[152:155]
    s_waitcnt vmcnt(8)
    ds_read_b128 v[176:179], v4 offset:28672
    v_mfma_f32_16x16x32_bf16 v[128:131], v[224:227], a[112:115], v[128:131]
    s_add_u32 s13, s84, s54
    ds_read_b128 v[164:167], v4 offset:25600
    v_mfma_f32_16x16x32_bf16 v[136:139], v[228:231], a[112:115], v[136:139]
    buffer_load_dwordx4 a[148:151], v6, s[64:67], s13 offen offset:256
    v_mfma_f32_16x16x32_bf16 v[144:147], v[232:235], a[112:115], v[144:147]
    buffer_load_dwordx4 a[152:155], v6, s[64:67], s13 offen offset:2304
    v_mfma_f32_16x16x32_bf16 v[152:155], v[236:239], a[112:115], v[152:155]
    s_waitcnt vmcnt(9) lgkmcnt(3)
    ds_read_b128 v[172:175], v4 offset:27648
    v_add_f32 v64, v64, v160
    v_mfma_f32_16x16x32_bf16 v[128:131], v[240:243], a[116:119], v[128:131]
    s_add_u32 s13, s84, s55
    ds_read_b128 v[180:183], v4 offset:29696
    v_add_f32 v65, v65, v161
    v_mfma_f32_16x16x32_bf16 v[136:139], v[244:247], a[116:119], v[136:139]
    buffer_load_dwordx4 a[156:159], v6, s[64:67], s13 offen offset:256
    v_mfma_f32_16x16x32_bf16 v[144:147], v[248:251], a[116:119], v[144:147]
    v_add_f32 v66, v66, v162
    v_add_f32 v67, v67, v163
    v_mfma_f32_16x16x32_bf16 v[152:155], v[252:255], a[116:119], v[152:155]
    s_waitcnt vmcnt(9) lgkmcnt(4)
    v_add_f32 v64, v64, v168
    v_add_f32 v65, v65, v169
    v_mfma_f32_16x16x32_bf16 v[128:131], v[16:19], a[120:123], v[128:131]
    buffer_load_dwordx4 a[160:163], v6, s[64:67], s13 offen offset:2304
    v_mfma_f32_16x16x32_bf16 v[136:139], v[20:23], a[120:123], v[136:139]
    s_add_u32 s13, s84, 16384
    v_add_f32 v66, v66, v170
    v_add_f32 v67, v67, v171
    v_mfma_f32_16x16x32_bf16 v[144:147], v[24:27], a[120:123], v[144:147]
    s_waitcnt lgkmcnt(3)
    v_add_f32 v64, v64, v176
    v_add_f32 v65, v65, v177
    v_mfma_f32_16x16x32_bf16 v[152:155], v[28:31], a[120:123], v[152:155]
    s_waitcnt vmcnt(9)
    v_add_f32 v66, v66, v178
    v_add_f32 v67, v67, v179
    v_mfma_f32_16x16x32_bf16 v[128:131], v[32:35], a[124:127], v[128:131]
    buffer_load_dwordx4 a[164:167], v6, s[64:67], s13 offen offset:256
    v_mfma_f32_16x16x32_bf16 v[136:139], v[36:39], a[124:127], v[136:139]
    v_fma_f32 v64, v64, v116, v184
    v_fma_f32 v65, v65, v116, v185
    v_mfma_f32_16x16x32_bf16 v[144:147], v[40:43], a[124:127], v[144:147]
    v_fma_f32 v66, v66, v116, v186
    v_fma_f32 v67, v67, v116, v187
    v_mfma_f32_16x16x32_bf16 v[152:155], v[44:47], a[124:127], v[152:155]
    s_waitcnt vmcnt(9)
    v_cvt_pk_bf16_f32 v96, v64, v65
    v_cvt_pk_bf16_f32 v97, v66, v67
    v_mfma_f32_16x16x32_bf16 v[128:131], v[48:51], a[128:131], v[128:131]
    buffer_load_dwordx4 a[168:171], v6, s[64:67], s13 offen offset:2304
    v_mfma_f32_16x16x32_bf16 v[136:139], v[52:55], a[128:131], v[136:139]
    s_add_u32 s13, s84, 20480
    ds_write_b64 v123, v[96:97]
    v_mfma_f32_16x16x32_bf16 v[144:147], v[56:59], a[128:131], v[144:147]
    s_waitcnt lgkmcnt(3)
    v_add_f32 v68, v68, v164
    v_add_f32 v69, v69, v165
    v_mfma_f32_16x16x32_bf16 v[152:155], v[60:63], a[128:131], v[152:155]
    s_waitcnt vmcnt(9)
    v_add_f32 v70, v70, v166
    v_add_f32 v71, v71, v167
    v_mfma_f32_16x16x32_bf16 v[140:143], a[196:199], a[132:135], 0
    buffer_load_dwordx4 a[172:175], v114, s[64:67], s13 offen offset:256
    v_mfma_f32_16x16x32_bf16 v[148:151], a[200:203], a[132:135], 0
    s_waitcnt lgkmcnt(2)
    v_add_f32 v68, v68, v172
    v_add_f32 v69, v69, v173
    v_mfma_f32_16x16x32_bf16 v[156:159], a[204:207], a[132:135], 0
    s_waitcnt vmcnt(9)
    v_add_f32 v70, v70, v174
    v_add_f32 v71, v71, v175
    v_mfma_f32_16x16x32_bf16 v[140:143], a[212:215], a[136:139], v[140:143]
    ds_write_b128 v1, v[136:139] offset:0
    v_mfma_f32_16x16x32_bf16 v[148:151], a[216:219], a[136:139], v[148:151]
    s_waitcnt lgkmcnt(2)
    v_add_f32 v68, v68, v180
    v_add_f32 v69, v69, v181
    v_mfma_f32_16x16x32_bf16 v[156:159], a[220:223], a[136:139], v[156:159]
    s_waitcnt vmcnt(8)
    ds_write_b128 v2, v[144:147] offset:0
    v_mfma_f32_16x16x32_bf16 v[140:143], a[228:231], a[140:143], v[140:143]
    v_add_f32 v70, v70, v182
    v_add_f32 v71, v71, v183
    v_mfma_f32_16x16x32_bf16 v[148:151], a[232:235], a[140:143], v[148:151]
    ds_write_b128 v3, v[152:155] offset:0
    v_mfma_f32_16x16x32_bf16 v[156:159], a[236:239], a[140:143], v[156:159]
    s_waitcnt vmcnt(7)
    v_fma_f32 v68, v68, v117, v188
    v_fma_f32 v69, v69, v117, v189
    v_mfma_f32_16x16x32_bf16 v[140:143], a[244:247], a[144:147], v[140:143]
    v_fma_f32 v70, v70, v117, v190
    v_fma_f32 v71, v71, v117, v191
    v_mfma_f32_16x16x32_bf16 v[148:151], a[248:251], a[144:147], v[148:151]
    v_cvt_pk_bf16_f32 v98, v68, v69
    v_cvt_pk_bf16_f32 v99, v70, v71
    v_mfma_f32_16x16x32_bf16 v[156:159], a[252:255], a[144:147], v[156:159]
    s_waitcnt vmcnt(6)
    ds_write_b64 v123, v[98:99] offset:2304
    v_mfma_f32_16x16x32_bf16 v[140:143], v[196:199], a[148:151], v[140:143]
    v_lshlrev_b32 v184, 16, v100
    v_and_b32 v185, 0xffff0000, v100
    v_mfma_f32_16x16x32_bf16 v[148:151], v[200:203], a[148:151], v[148:151]
    v_lshlrev_b32 v186, 16, v101
    v_and_b32 v187, 0xffff0000, v101
    v_mfma_f32_16x16x32_bf16 v[156:159], v[204:207], a[148:151], v[156:159]
    s_waitcnt vmcnt(5)
    v_lshlrev_b32 v188, 16, v102
    v_and_b32 v189, 0xffff0000, v102
    v_mfma_f32_16x16x32_bf16 v[140:143], v[212:215], a[152:155], v[140:143]
    s_waitcnt lgkmcnt(0)
    s_barrier
    v_mfma_f32_16x16x32_bf16 v[148:151], v[216:219], a[152:155], v[148:151]
    ds_read_b128 v[72:75], v4 offset:0
    v_lshlrev_b32 v190, 16, v103
    v_mfma_f32_16x16x32_bf16 v[156:159], v[220:223], a[152:155], v[156:159]
    s_waitcnt vmcnt(4)
    ds_read_b128 v[76:79], v4 offset:2048
    v_and_b32 v191, 0xffff0000, v103
    v_mfma_f32_16x16x32_bf16 v[140:143], v[228:231], a[156:159], v[140:143]
    ds_read_b128 v[80:83], v4 offset:4096
    ds_read_b128 v[96:99], v124
    v_mfma_f32_16x16x32_bf16 v[148:151], v[232:235], a[156:159], v[148:151]
    v_mfma_f32_16x16x32_bf16 v[156:159], v[236:239], a[156:159], v[156:159]
    s_waitcnt vmcnt(3)
    v_mfma_f32_16x16x32_bf16 v[140:143], v[244:247], a[160:163], v[140:143]
    v_mfma_f32_16x16x32_bf16 v[148:151], v[248:251], a[160:163], v[148:151]
    v_mfma_f32_16x16x32_bf16 v[156:159], v[252:255], a[160:163], v[156:159]
    s_waitcnt vmcnt(2) lgkmcnt(0)
    buffer_store_dwordx4 v[96:99], v125, s[56:59], s88 offen sc1
    v_mfma_f32_16x16x32_bf16 v[140:143], v[20:23], a[164:167], v[140:143]
    v_add_f32 v128, v128, v72
    v_add_f32 v129, v129, v73
    v_mfma_f32_16x16x32_bf16 v[148:151], v[24:27], a[164:167], v[148:151]
    v_add_f32 v130, v130, v74
    v_add_f32 v131, v131, v75
    v_mfma_f32_16x16x32_bf16 v[156:159], v[28:31], a[164:167], v[156:159]
    s_waitcnt vmcnt(2)
    v_add_f32 v128, v128, v76
    v_add_f32 v129, v129, v77
    v_mfma_f32_16x16x32_bf16 v[140:143], v[36:39], a[168:171], v[140:143]
    v_add_f32 v130, v130, v78
    v_add_f32 v131, v131, v79
    v_mfma_f32_16x16x32_bf16 v[148:151], v[40:43], a[168:171], v[148:151]
    v_add_f32 v128, v128, v80
    v_add_f32 v129, v129, v81
    v_mfma_f32_16x16x32_bf16 v[156:159], v[44:47], a[168:171], v[156:159]
    s_waitcnt vmcnt(1)
    v_add_f32 v130, v130, v82
    v_add_f32 v131, v131, v83
    v_mfma_f32_16x16x32_bf16 v[140:143], v[52:55], a[172:175], v[140:143]
    v_fma_f32 v128, v128, v118, v184
    v_fma_f32 v129, v129, v118, v185
    v_mfma_f32_16x16x32_bf16 v[148:151], v[56:59], a[172:175], v[148:151]
    v_fma_f32 v130, v130, v118, v186
    v_fma_f32 v131, v131, v118, v187
    v_mfma_f32_16x16x32_bf16 v[156:159], v[60:63], a[172:175], v[156:159]
    v_cvt_pk_bf16_f32 v100, v128, v129
    v_cvt_pk_bf16_f32 v101, v130, v131
    v_mfma_f32_16x16x32_bf16 v[132:135], a[192:195], a[132:135], 0
    v_permlane32_swap_b32 v100, v102
    v_mfma_f32_16x16x32_bf16 v[132:135], a[208:211], a[136:139], v[132:135]
    ds_write_b128 v1, v[140:143] offset:1024
    v_mfma_f32_16x16x32_bf16 v[132:135], a[224:227], a[140:143], v[132:135]
    ds_write_b128 v2, v[148:151] offset:1024
    v_mfma_f32_16x16x32_bf16 v[132:135], a[240:243], a[144:147], v[132:135]
    ds_write_b128 v3, v[156:159] offset:1024
    v_mfma_f32_16x16x32_bf16 v[132:135], v[192:195], a[148:151], v[132:135]
    v_permlane32_swap_b32 v101, v103
    v_mfma_f32_16x16x32_bf16 v[132:135], v[208:211], a[152:155], v[132:135]
    s_mov_b32 exec_hi, 0
    buffer_store_dwordx4 v[100:103], v11, s[56:59], s89 offen
    s_mov_b32 exec_hi, -1
    v_mfma_f32_16x16x32_bf16 v[132:135], v[224:227], a[156:159], v[132:135]
    s_waitcnt lgkmcnt(0)
    s_barrier
    v_mfma_f32_16x16x32_bf16 v[132:135], v[240:243], a[160:163], v[132:135]
    ds_read_b128 v[164:167], v4 offset:1024
    ds_read_b128 v[172:175], v4 offset:3072
    v_mfma_f32_16x16x32_bf16 v[132:135], v[16:19], a[164:167], v[132:135]
    ds_read_b128 v[180:183], v4 offset:5120
    v_mfma_f32_16x16x32_bf16 v[132:135], v[32:35], a[168:171], v[132:135]
    v_mfma_f32_16x16x32_bf16 v[132:135], v[48:51], a[172:175], v[132:135]
    s_waitcnt lgkmcnt(1)
    v_pk_add_f32 v[164:165], v[164:165], v[172:173]
    v_pk_add_f32 v[166:167], v[166:167], v[174:175]
    v_pk_fma_f32 v[164:165], v[164:165], v[118:119], v[188:189] op_sel:[0,1,0] op_sel_hi:[1,1,1]
    v_pk_fma_f32 v[166:167], v[166:167], v[118:119], v[190:191] op_sel:[0,1,0] op_sel_hi:[1,1,1]
    s_waitcnt lgkmcnt(0)
    s_nop 1
    v_pk_add_f32 v[132:133], v[132:133], v[180:181]
    v_pk_add_f32 v[134:135], v[134:135], v[182:183]
    v_pk_fma_f32 v[132:133], v[132:133], v[118:119], v[164:165] op_sel:[0,1,0] op_sel_hi:[1,1,1]
    v_pk_fma_f32 v[134:135], v[134:135], v[118:119], v[166:167] op_sel:[0,1,0] op_sel_hi:[1,1,1]
    v_cvt_pk_bf16_f32 v102, v132, v133
    v_cvt_pk_bf16_f32 v103, v134, v135
    s_nop 0
    v_permlane32_swap_b32 v100, v102
    v_permlane32_swap_b32 v101, v103
    s_mov_b32 exec_lo, 0
    buffer_store_dwordx4 v[100:103], v11, s[56:59], s89 offen
    s_endpgm
PS_32:
    s_mov_b32 s92, s85
    s_mov_b32 s93, 0
    s_mov_b64 s[20:21], -1
    s_mov_b64 s[22:23], s[74:75]
PS_32p:
    buffer_load_dwordx2 v[120:121], v115, s[64:67], s92 offen offset:0 sc1
    s_add_u32 s93, s93, 1
    s_waitcnt vmcnt(0)
    v_cmp_ne_u64 vcc, s[22:23], v[120:121]
    s_cmp_gt_u32 s93, 400000
    s_cbranch_scc1 PR_33
    s_and_b64 s[20:21], s[20:21], vcc
    s_cbranch_scc0 PR_33
    s_branch PS_32p
PS_34:
    s_mov_b32 s92, s10
    s_mov_b32 s93, 0
    s_mov_b64 s[20:21], -1
    s_mov_b64 s[22:23], s[18:19]
PS_34p:
    buffer_load_dwordx2 v[120:121], v15, s[64:67], s92 offen offset:0 sc1
    s_add_u32 s93, s93, 1
    s_waitcnt vmcnt(0)
    v_cmp_ne_u64 vcc, s[22:23], v[120:121]
    s_cmp_gt_u32 s93, 400000
    s_cbranch_scc1 PR_35
    s_and_b64 s[20:21], s[20:21], vcc
    s_cbranch_scc0 PR_35
    s_cmp_eq_u32 s17, 0
    s_cbranch_scc1 PS_34p
    s_xor_b32 s92, s92, 98304
    s_xor_b32 s94, s19, s75
    s_xor_b32 s23, s23, s94
    s_branch PS_34p
PS_36:
    s_mov_b32 s92, s10
    s_mov_b32 s93, 0
    s_mov_b64 s[20:21], -1
    s_mov_b64 s[22:23], s[18:19]
PS_36p:
    buffer_load_dwordx2 v[120:121], v15, s[64:67], s92 offen offset:512 sc1
    s_add_u32 s93, s93, 1
    s_waitcnt vmcnt(0)
    v_cmp_ne_u64 vcc, s[22:23], v[120:121]
    s_cmp_gt_u32 s93, 400000
    s_cbranch_scc1 PR_37
    s_and_b64 s[20:21], s[20:21], vcc
    s_cbranch_scc0 PR_37
    s_cmp_eq_u32 s17, 0
    s_cbranch_scc1 PS_36p
    s_xor_b32 s92, s92, 98304
    s_xor_b32 s94, s19, s75
    s_xor_b32 s23, s23, s94
    s_branch PS_36p
PS_38:
    s_mov_b32 s92, s10
    s_mov_b32 s93, 0
    s_mov_b64 s[20:21], -1
    s_mov_b64 s[22:23], s[18:19]
PS_38p:
    buffer_load_dwordx2 v[120:121], v15, s[64:67], s92 offen offset:1024 sc1
    s_add_u32 s93, s93, 1
    s_waitcnt vmcnt(0)
    v_cmp_ne_u64 vcc, s[22:23], v[120:121]
    s_cmp_gt_u32 s93, 400000
    s_cbranch_scc1 PR_39
    s_and_b64 s[20:21], s[20:21], vcc
    s_cbranch_scc0 PR_39
    s_cmp_eq_u32 s17, 0
    s_cbranch_scc1 PS_38p
    s_xor_b32 s92, s92, 98304
    s_xor_b32 s94, s19, s75
    s_xor_b32 s23, s23, s94
    s_branch PS_38p
SX_15:
    s_waitcnt vmcnt(0) lgkmcnt(0)
    s_mov_b32 s17, 1
    s_lshl_b32 s94, s69, 10
    s_add_u32 s94, s94, 12976128
    v_and_b32 v122, 1, v0
    v_lshlrev_b32 v122, 5, v122
    v_bfe_u32 v120, v0, 1, 1
    v_add_u32 v122, v122, v120
    v_lshlrev_b32 v122, 3, v122
    s_lshl_b32 s93, s70, 4
    v_add_u32 v122, s93, v122
    s_mov_b32 s93, 0
SW_16:
    buffer_load_dwordx2 v[120:121], v122, s[64:67], s15 offen sc1
    s_add_u32 s93, s93, 1
    s_waitcnt vmcnt(0)
    v_cmp_ne_u64 vcc, s[18:19], v[120:121]
    s_cmp_gt_u32 s93, 400000
    s_cbranch_scc1 SW_17
    s_nop 2
    s_cbranch_vccnz SW_16
SW_17:
    v_mov_b32 v120, s74
    v_mov_b32 v121, s75
    s_mov_b64 exec, 15
    buffer_store_dwordx2 v[120:121], v122, s[64:67], s94 offen sc1
    s_mov_b64 exec, -1
    s_waitcnt vmcnt(0)
    v_and_b32 v122, 7, v0
    v_lshl_add_u32 v122, v122, 3, s92
    s_xor_b32 s95, s94, s15
    s_mov_b32 s93, 0
    s_mov_b64 s[20:21], -1
    s_mov_b64 s[22:23], s[74:75]
SV_14:
    buffer_load_dwordx2 v[120:121], v122, s[64:67], s94 offen sc1
    s_add_u32 s93, s93, 1
    s_xor_b32 s94, s94, s95
    s_waitcnt vmcnt(0)
    v_cmp_ne_u64 vcc, s[22:23], v[120:121]
    s_xor_b32 s92, s19, s75
    s_xor_b32 s23, s23, s92
    s_cmp_gt_u32 s93, 400000
    s_cbranch_scc1 SD_12
    s_and_b64 s[20:21], s[20:21], vcc
    s_cbranch_scc1 SV_14
    s_branch SD_12
SX_23:
    s_waitcnt vmcnt(0) lgkmcnt(0)
    s_mov_b32 s17, 1
    s_lshl_b32 s94, s69, 10
    s_add_u32 s94, s94, 12976128
    v_and_b32 v122, 1, v0
    v_lshlrev_b32 v122, 5, v122
    v_bfe_u32 v120, v0, 1, 1
    v_add_u32 v122, v122, v120
    v_lshlrev_b32 v122, 3, v122
    s_lshl_b32 s93, s70, 4
    v_add_u32 v122, s93, v122
    s_lshl3_add_u32 s93, s70, 512
    v_writelane_b32 v122, s93, 4
    v_mov_b32 v120, s74
    v_mov_b32 v121, s75
    s_mov_b64 exec, 31
    buffer_store_dwordx2 v[120:121], v122, s[64:67], s94 offen sc1
    s_mov_b64 exec, -1
    s_waitcnt vmcnt(0)
    v_and_b32 v122, 3, v0
    v_lshl_add_u32 v122, v122, 3, s92
    s_xor_b32 s95, s94, s15
    s_mov_b32 s93, 0
    s_mov_b64 s[20:21], -1
    s_mov_b64 s[22:23], s[74:75]
SV_22:
    buffer_load_dwordx2 v[120:121], v122, s[64:67], s94 offen sc1
    s_add_u32 s93, s93, 1
    s_xor_b32 s94, s94, s95
    s_waitcnt vmcnt(0)
    v_cmp_ne_u64 vcc, s[22:23], v[120:121]
    s_xor_b32 s92, s19, s75
    s_xor_b32 s23, s23, s92
    s_cmp_gt_u32 s93, 400000
    s_cbranch_scc1 SD_20
    s_and_b64 s[20:21], s[20:21], vcc
    s_cbranch_scc1 SV_22
    s_branch SD_20
FG_26:
    s_add_u32 s92, s14, 32768
    v_mov_b32 v110, s74
    v_mov_b32 v111, s75
    buffer_store_dwordx2 v[110:111], v5, s[64:67], s92 offen offset:0 sc1
    s_waitcnt vmcnt(0)
    s_branch FR_27
FG_28:
    s_add_u32 s92, s14, 32768
    v_mov_b32 v110, s74
    v_mov_b32 v111, s75
    buffer_store_dwordx2 v[110:111], v5, s[64:67], s92 offen offset:512 sc1
    s_waitcnt vmcnt(0)
    s_branch FR_29
FG_30:
    s_add_u32 s92, s14, 32768
    v_mov_b32 v110, s74
    v_mov_b32 v111, s75
    buffer_store_dwordx2 v[110:111], v5, s[64:67], s92 offen offset:1024 sc1
    s_waitcnt vmcnt(0)
    s_branch FR_31
L_end:
s_endpgm
.section .rodata,"a"
.p2align 6
.amdhsa_kernel sequential_preLN__linear_kernel_hedgehog__glu_gated_bilinear__prompt_kernel
  .amdhsa_next_free_vgpr 512
  .amdhsa_next_free_sgpr 102
  .amdhsa_accum_offset 256
  .amdhsa_group_segment_fixed_size 0
  .amdhsa_kernarg_size 88
  .amdhsa_user_sgpr_count 2
  .amdhsa_user_sgpr_kernarg_segment_ptr 1
  .amdhsa_system_sgpr_workgroup_id_x 1
.end_amdhsa_kernel
```
